```python
import torch

def _softmax(x, axis=-1):
    return torch.softmax(x, dim=axis)
def _gelu(x):
    return torch.nn.functional.gelu(x, approximate="tanh")
def _silu(x):
    return torch.nn.functional.silu(x)
def _sigmoid(x):
    return torch.sigmoid(x)
def _layernorm(x, axis=-1, eps=1e-5):
    m = x.mean(dim=axis, keepdim=True)
    v = x.var(dim=axis, keepdim=True, unbiased=False)
    return (x - m) / torch.sqrt(v + eps)
def _scatter_add(tgt, idx, src, axis=0):
    return tgt.clone().index_add_(axis, idx, src)
def _segment_sum(src, seg, n):
    out = torch.zeros((n,) + src.shape[1:], dtype=src.dtype)
    return out.index_add_(0, seg, src)
def _pad(x, pw):
    flat = tuple(v for pair in reversed(pw) for v in pair)
    return torch.nn.functional.pad(x, flat)

kernel_name = 'standalone__gqa_block_cached__near_ridge'

def setup_inputs():

    _w = (lambda a: (lambda t: t.to(torch.bfloat16) if t.is_floating_point() else t)(torch.as_tensor(a)))
    B, Sq, D = 8, 112, 640
    Hq, Hkv, Sk, Dh = 32, 32, 512, 128
    assert Hq % Hkv == 0, (Hq, Hkv)
    return {
        "x": _w((lambda *s: torch.randn(*s, dtype=torch.bfloat16) * 0.8)(B, Sq, D)),
        "k_cache": _w((lambda *s: torch.randn(*s, dtype=torch.bfloat16) * 0.8)(B, Hkv, Sk, Dh)),
        "v_cache": _w((lambda *s: torch.randn(*s, dtype=torch.bfloat16) * 0.05)(B, Hkv, Sk, Dh)),
        "wq": _w((lambda *s: torch.randn(*s, dtype=torch.bfloat16) * 0.8)(D, Hq * Dh) * (D ** -0.5)),
        "wo": _w((lambda *s: torch.randn(*s, dtype=torch.bfloat16) * 0.05)(Hq * Dh, D) * ((Hq * Dh) ** -0.5)),
    }

def reference(x, k_cache, v_cache, wq, wo):
    B, Sq, D = x.shape
    Hq, Dh = 32, 128
    Hkv = k_cache.shape[1]
    rep = Hq // Hkv
    q = (lambda x, *d: x.permute(*d))((x @ wq).reshape(B, Sq, Hq, Dh), 0, 2, 1, 3)
    k = (lambda x, n, axis: torch.repeat_interleave(x, n, dim=axis))(k_cache, rep, axis=1)
    v = (lambda x, n, axis: torch.repeat_interleave(x, n, dim=axis))(v_cache, rep, axis=1)
    scores = torch.einsum("bhqd,bhkd->bhqk", q, k) * (Dh ** -0.5)
    p = _softmax(scores, axis=-1)
    o = torch.einsum("bhqk,bhkd->bhqd", p, v)
    return (lambda x, *d: x.permute(*d))(o, 0, 2, 1, 3).reshape(B, Sq, Hq * Dh) @ wo
```

```asm
; @launch kernel=attn_kernel grid=(256,1,1) block=(512,1,1) lds=163840
; @launch kernel=oproj_kernel grid=(256,1,1) block=(512,1,1) lds=163840
; @launch kernel=reduce_kernel grid=(160,1,1) block=(256,1,1) lds=0
.amdgcn_target "amdgcn-amd-amdhsa--gfx950"
.text
.globl attn_kernel
.p2align 8
.type attn_kernel,@function
attn_kernel:
  s_load_dwordx4 s[36:39], s[0:1], 0
  s_load_dwordx4 s[40:43], s[0:1], 16
  s_load_dwordx2 s[46:47], s[0:1], 32
  s_load_dwordx4 s[52:55], s[0:1], 48
  s_cmp_ge_u32 s2, 0x100
  s_cbranch_scc1 .LEND_F
  v_and_b32 v224, 63, v0
  v_lshrrev_b32 v250, 6, v0
  s_nop 0
  v_readfirstlane_b32 s24, v250
  s_nop 3
  s_lshr_b32 s25, s24, 2
  s_and_b32 s26, s24, 3
  s_lshr_b32 s27, s2, 5
  s_and_b32 s28, s2, 31
  s_and_b32 s34, s2, 7
  s_lshr_b32 s35, s28, 3
  s_mov_b32 s32, 0x3e0293ee
  s_lshl_b32 s31, s26, 12
  s_waitcnt lgkmcnt(0)
  s_mov_b32 s44, s54
  s_mov_b32 s45, s55
  s_mov_b32 s4, s36
  s_and_b32 s5, s37, 0xffff
  s_mov_b32 s6, 0x118000
  s_mov_b32 s7, 0x20000
  s_mov_b32 s8, s42
  s_and_b32 s9, s43, 0xffff
  s_mov_b32 s10, 0x500000
  s_mov_b32 s11, 0x20000
  s_lshl_b32 s29, s2, 17
  s_add_u32 s12, s38, s29
  s_addc_u32 s13, s39, 0
  s_and_b32 s13, s13, 0xffff
  s_mov_b32 s14, 0x20000
  s_mov_b32 s15, 0x20000
  s_add_u32 s16, s40, s29
  s_addc_u32 s17, s41, 0
  s_and_b32 s17, s17, 0xffff
  s_mov_b32 s18, 0x20000
  s_mov_b32 s19, 0x20000
  s_mov_b32 s20, s54
  s_and_b32 s21, s55, 0xffff
  s_mov_b32 s22, 0x800000
  s_mov_b32 s23, 0x20000
  s_mov_b32 s56, s46
  s_and_b32 s57, s47, 0xffff
  s_mov_b32 s58, 0x500000
  s_mov_b32 s59, 0x20000
  s_mov_b32 s29, 0x800000
  s_add_u32 s60, s54, s29
  s_addc_u32 s61, s55, 0
  s_and_b32 s61, s61, 0xffff
  s_mov_b32 s62, 0xa00000
  s_mov_b32 s63, 0x20000
  s_mov_b32 s64, s52
  s_and_b32 s65, s53, 0xffff
  s_mov_b32 s66, 0x100
  s_mov_b32 s67, 0x20000
  s_cmp_lg_u32 s25, 0
  s_cbranch_scc1 .LROLE1
  s_mul_i32 s29, s27, 0x70
  s_lshl_b32 s30, s26, 5
  s_add_u32 s29, s29, s30
  v_lshrrev_b32 v250, 2, v224
  v_add_u32 v250, s29, v250
  v_mul_u32_u24 v250, 0x500, v250
  v_lshrrev_b32 v251, 4, v224
  v_xor_b32 v251, v251, v224
  v_and_b32 v251, 3, v251
  v_lshl_add_u32 v230, v251, 4, v250
  v_add_u32 v231, 0x4c00, v230
  v_lshrrev_b32 v250, 4, v224
  v_lshlrev_b32 v251, 2, v250
  v_xor_b32 v251, v251, v224
  v_and_b32 v251, 15, v251
  s_lshl_b32 s29, s26, 3
  v_add_u32 v250, s29, v250
  v_lshlrev_b32 v250, 13, v250
  v_lshl_add_u32 v250, v251, 4, v250
  s_lshl_b32 s29, s28, 8
  v_add_u32 v232, s29, v250
  v_add_u32 v233, 0x7c00, v232
  s_lshl_b32 s29, s26, 11
  s_add_u32 m0, s29, 0
  s_mov_b32 s30, 0
  buffer_load_dwordx4 v230, s[4:7], s30 offen lds
  buffer_load_dwordx4 v231, s[4:7], s30 offen offset:1024 lds
  s_add_u32 m0, s29, 0x2000
  s_mov_b32 s30, 0
  buffer_load_dwordx4 v232, s[8:11], s30 offen lds
  buffer_load_dwordx4 v233, s[8:11], s30 offen offset:1024 lds
  s_lshl_b32 s29, s26, 11
  s_add_u32 m0, s29, 0x4000
  s_mov_b32 s30, 64
  buffer_load_dwordx4 v230, s[4:7], s30 offen lds
  buffer_load_dwordx4 v231, s[4:7], s30 offen offset:1024 lds
  s_add_u32 m0, s29, 0x6000
  s_mov_b32 s30, 0x40000
  buffer_load_dwordx4 v232, s[8:11], s30 offen lds
  buffer_load_dwordx4 v233, s[8:11], s30 offen offset:1024 lds
  s_lshl_b32 s29, s26, 11
  s_add_u32 m0, s29, 0x8000
  s_mov_b32 s30, 0x80
  buffer_load_dwordx4 v230, s[4:7], s30 offen lds
  buffer_load_dwordx4 v231, s[4:7], s30 offen offset:1024 lds
  s_add_u32 m0, s29, 0xa000
  s_mov_b32 s30, 0x80000
  buffer_load_dwordx4 v232, s[8:11], s30 offen lds
  buffer_load_dwordx4 v233, s[8:11], s30 offen offset:1024 lds
  s_lshl_b32 s29, s26, 11
  s_add_u32 m0, s29, 0xc000
  s_mov_b32 s30, 0xc0
  buffer_load_dwordx4 v230, s[4:7], s30 offen lds
  buffer_load_dwordx4 v231, s[4:7], s30 offen offset:1024 lds
  s_add_u32 m0, s29, 0xe000
  s_mov_b32 s30, 0xc0000
  buffer_load_dwordx4 v232, s[8:11], s30 offen lds
  buffer_load_dwordx4 v233, s[8:11], s30 offen offset:1024 lds
  s_lshl_b32 s29, s26, 11
  s_add_u32 m0, s29, 0x10000
  s_mov_b32 s30, 0x100
  buffer_load_dwordx4 v230, s[4:7], s30 offen lds
  buffer_load_dwordx4 v231, s[4:7], s30 offen offset:1024 lds
  s_add_u32 m0, s29, 0x12000
  s_mov_b32 s30, 0x100000
  buffer_load_dwordx4 v232, s[8:11], s30 offen lds
  buffer_load_dwordx4 v233, s[8:11], s30 offen offset:1024 lds
  s_lshl_b32 s29, s26, 11
  s_add_u32 m0, s29, 0x14000
  s_mov_b32 s30, 0x140
  buffer_load_dwordx4 v230, s[4:7], s30 offen lds
  buffer_load_dwordx4 v231, s[4:7], s30 offen offset:1024 lds
  s_add_u32 m0, s29, 0x16000
  s_mov_b32 s30, 0x140000
  buffer_load_dwordx4 v232, s[8:11], s30 offen lds
  buffer_load_dwordx4 v233, s[8:11], s30 offen offset:1024 lds
  s_lshl_b32 s29, s26, 11
  s_add_u32 m0, s29, 0x18000
  s_mov_b32 s30, 0x180
  buffer_load_dwordx4 v230, s[4:7], s30 offen lds
  buffer_load_dwordx4 v231, s[4:7], s30 offen offset:1024 lds
  s_add_u32 m0, s29, 0x1a000
  s_mov_b32 s30, 0x180000
  buffer_load_dwordx4 v232, s[8:11], s30 offen lds
  buffer_load_dwordx4 v233, s[8:11], s30 offen offset:1024 lds
  s_lshl_b32 s29, s26, 11
  s_add_u32 m0, s29, 0x1c000
  s_mov_b32 s30, 0x1c0
  buffer_load_dwordx4 v230, s[4:7], s30 offen lds
  buffer_load_dwordx4 v231, s[4:7], s30 offen offset:1024 lds
  s_add_u32 m0, s29, 0x1e000
  s_mov_b32 s30, 0x1c0000
  buffer_load_dwordx4 v232, s[8:11], s30 offen lds
  buffer_load_dwordx4 v233, s[8:11], s30 offen offset:1024 lds
  s_lshl_b32 s29, s26, 11
  s_add_u32 m0, s29, 0x20000
  s_mov_b32 s30, 0x200
  buffer_load_dwordx4 v230, s[4:7], s30 offen lds
  buffer_load_dwordx4 v231, s[4:7], s30 offen offset:1024 lds
  s_add_u32 m0, s29, 0x22000
  s_mov_b32 s30, 0x200000
  buffer_load_dwordx4 v232, s[8:11], s30 offen lds
  buffer_load_dwordx4 v233, s[8:11], s30 offen offset:1024 lds
  s_lshl_b32 s29, s26, 11
  s_add_u32 m0, s29, 0x24000
  s_mov_b32 s30, 0x240
  buffer_load_dwordx4 v230, s[4:7], s30 offen lds
  buffer_load_dwordx4 v231, s[4:7], s30 offen offset:1024 lds
  s_add_u32 m0, s29, 0x26000
  s_mov_b32 s30, 0x240000
  buffer_load_dwordx4 v232, s[8:11], s30 offen lds
  buffer_load_dwordx4 v233, s[8:11], s30 offen offset:1024 lds
  v_and_b32 v250, 31, v224
  v_lshrrev_b32 v251, 5, v224
  s_lshl_b32 s29, s26, 5
  v_add_u32 v253, s29, v250
  v_lshrrev_b32 v255, 2, v253
  v_and_b32 v255, 3, v255
  v_xor_b32 v255, v255, v251
  v_lshlrev_b32 v253, 6, v253
  v_lshl_add_u32 v225, v255, 4, v253
  v_add_u32 v225, 0, v225
  v_xor_b32 v226, 32, v225
  v_lshrrev_b32 v247, 2, v224
  v_and_b32 v247, 3, v247
  v_and_b32 v248, 1, v224
  v_lshlrev_b32 v248, 4, v248
  v_and_b32 v253, 2, v224
  v_lshl_add_u32 v248, v253, 2, v248
  v_and_b32 v253, 16, v224
  v_lshl_add_u32 v248, v253, 1, v248
  v_lshl_add_u32 v253, v251, 3, v247
  v_lshl_add_u32 v253, v253, 8, v248
  v_add_u32 v253, 0x2000, v253
  v_xor_b32 v255, 0, v247
  v_lshl_add_u32 v227, v255, 6, v253
  v_lshl_add_u32 v253, v251, 2, v247
  v_lshl_add_u32 v253, v253, 8, v248
  v_xor_b32 v255, 0, v247
  v_lshl_add_u32 v243, v255, 6, v253
  v_xor_b32 v255, 1, v247
  v_lshl_add_u32 v244, v255, 6, v253
  v_xor_b32 v255, 2, v247
  v_lshl_add_u32 v245, v255, 6, v253
  v_xor_b32 v255, 3, v247
  v_lshl_add_u32 v246, v255, 6, v253
  v_add_u32 v253, 0, v250
  v_and_b32 v255, 15, v253
  v_xor_b32 v255, v255, v251
  v_lshlrev_b32 v253, 8, v253
  v_lshl_add_u32 v235, v255, 4, v253
  v_xor_b32 v236, 32, v235
  v_xor_b32 v237, 64, v235
  v_xor_b32 v238, 0x60, v235
  v_xor_b32 v239, 0x80, v235
  v_xor_b32 v240, 0xa0, v235
  v_xor_b32 v241, 0xc0, v235
  v_xor_b32 v242, 0xe0, v235
  s_waitcnt vmcnt(36)
  s_barrier
  ds_read_b128 v[0:3], v225
  ds_read_b64_tr_b16 v[8:9], v227
  ds_read_b64_tr_b16 v[10:11], v227 offset:1024
  ds_read_b128 v[4:7], v226
  ds_read_b64_tr_b16 v[12:13], v227 offset:4096
  ds_read_b64_tr_b16 v[14:15], v227 offset:5120
  s_waitcnt lgkmcnt(0)
  s_waitcnt vmcnt(32)
  s_barrier
  ds_read_b128 v[16:19], v225 offset:16384
  ds_read_b64_tr_b16 v[24:25], v227 offset:16384
  ds_read_b64_tr_b16 v[26:27], v227 offset:17408
  ds_read_b128 v[20:23], v226 offset:16384
  ds_read_b64_tr_b16 v[28:29], v227 offset:20480
  ds_read_b64_tr_b16 v[30:31], v227 offset:21504
  v_mfma_f32_32x32x16_bf16 v[128:143], v[8:11], v[0:3], 0
  v_mfma_f32_32x32x16_bf16 v[128:143], v[12:15], v[4:7], v[128:143]
  s_lshl_b32 s29, s26, 11
  s_add_u32 m0, s29, 0
  s_mov_b32 s30, 0x280
  buffer_load_dwordx4 v230, s[4:7], s30 offen lds
  buffer_load_dwordx4 v231, s[4:7], s30 offen offset:1024 lds
  s_add_u32 m0, s29, 0x2000
  s_mov_b32 s30, 0x280000
  buffer_load_dwordx4 v232, s[8:11], s30 offen lds
  buffer_load_dwordx4 v233, s[8:11], s30 offen offset:1024 lds
  s_waitcnt lgkmcnt(0)
  s_waitcnt vmcnt(32)
  s_barrier
  ds_read_b128 v[0:3], v225 offset:32768
  ds_read_b64_tr_b16 v[8:9], v227 offset:32768
  ds_read_b64_tr_b16 v[10:11], v227 offset:33792
  ds_read_b128 v[4:7], v226 offset:32768
  ds_read_b64_tr_b16 v[12:13], v227 offset:36864
  ds_read_b64_tr_b16 v[14:15], v227 offset:37888
  v_mfma_f32_32x32x16_bf16 v[128:143], v[24:27], v[16:19], v[128:143]
  v_mfma_f32_32x32x16_bf16 v[128:143], v[28:31], v[20:23], v[128:143]
  s_lshl_b32 s29, s26, 11
  s_add_u32 m0, s29, 0x4000
  s_mov_b32 s30, 0x2c0
  buffer_load_dwordx4 v230, s[4:7], s30 offen lds
  buffer_load_dwordx4 v231, s[4:7], s30 offen offset:1024 lds
  s_add_u32 m0, s29, 0x6000
  s_mov_b32 s30, 0x2c0000
  buffer_load_dwordx4 v232, s[8:11], s30 offen lds
  buffer_load_dwordx4 v233, s[8:11], s30 offen offset:1024 lds
  s_waitcnt lgkmcnt(0)
  s_waitcnt vmcnt(32)
  s_barrier
  ds_read_b128 v[16:19], v225 offset:49152
  ds_read_b64_tr_b16 v[24:25], v227 offset:49152
  ds_read_b64_tr_b16 v[26:27], v227 offset:50176
  ds_read_b128 v[20:23], v226 offset:49152
  ds_read_b64_tr_b16 v[28:29], v227 offset:53248
  ds_read_b64_tr_b16 v[30:31], v227 offset:54272
  v_mfma_f32_32x32x16_bf16 v[128:143], v[8:11], v[0:3], v[128:143]
  v_mfma_f32_32x32x16_bf16 v[128:143], v[12:15], v[4:7], v[128:143]
  s_lshl_b32 s29, s26, 11
  s_add_u32 m0, s29, 0x8000
  s_mov_b32 s30, 0x300
  buffer_load_dwordx4 v230, s[4:7], s30 offen lds
  buffer_load_dwordx4 v231, s[4:7], s30 offen offset:1024 lds
  s_add_u32 m0, s29, 0xa000
  s_mov_b32 s30, 0x300000
  buffer_load_dwordx4 v232, s[8:11], s30 offen lds
  buffer_load_dwordx4 v233, s[8:11], s30 offen offset:1024 lds
  s_waitcnt lgkmcnt(0)
  s_waitcnt vmcnt(32)
  s_barrier
  v_add_u32 v225, 0x10000, v225
  v_add_u32 v226, 0x10000, v226
  v_add_u32 v227, 0x10000, v227
  ds_read_b128 v[0:3], v225
  ds_read_b64_tr_b16 v[8:9], v227
  ds_read_b64_tr_b16 v[10:11], v227 offset:1024
  ds_read_b128 v[4:7], v226
  ds_read_b64_tr_b16 v[12:13], v227 offset:4096
  ds_read_b64_tr_b16 v[14:15], v227 offset:5120
  v_mfma_f32_32x32x16_bf16 v[128:143], v[24:27], v[16:19], v[128:143]
  v_mfma_f32_32x32x16_bf16 v[128:143], v[28:31], v[20:23], v[128:143]
  s_lshl_b32 s29, s26, 11
  s_add_u32 m0, s29, 0xc000
  s_mov_b32 s30, 0x340
  buffer_load_dwordx4 v230, s[4:7], s30 offen lds
  buffer_load_dwordx4 v231, s[4:7], s30 offen offset:1024 lds
  s_add_u32 m0, s29, 0xe000
  s_mov_b32 s30, 0x340000
  buffer_load_dwordx4 v232, s[8:11], s30 offen lds
  buffer_load_dwordx4 v233, s[8:11], s30 offen offset:1024 lds
  s_waitcnt lgkmcnt(0)
  s_waitcnt vmcnt(32)
  s_barrier
  ds_read_b128 v[16:19], v225 offset:16384
  ds_read_b64_tr_b16 v[24:25], v227 offset:16384
  ds_read_b64_tr_b16 v[26:27], v227 offset:17408
  ds_read_b128 v[20:23], v226 offset:16384
  ds_read_b64_tr_b16 v[28:29], v227 offset:20480
  ds_read_b64_tr_b16 v[30:31], v227 offset:21504
  v_mfma_f32_32x32x16_bf16 v[128:143], v[8:11], v[0:3], v[128:143]
  v_mfma_f32_32x32x16_bf16 v[128:143], v[12:15], v[4:7], v[128:143]
  s_lshl_b32 s29, s26, 11
  s_add_u32 m0, s29, 0x10000
  s_mov_b32 s30, 0x380
  buffer_load_dwordx4 v230, s[4:7], s30 offen lds
  buffer_load_dwordx4 v231, s[4:7], s30 offen offset:1024 lds
  s_add_u32 m0, s29, 0x12000
  s_mov_b32 s30, 0x380000
  buffer_load_dwordx4 v232, s[8:11], s30 offen lds
  buffer_load_dwordx4 v233, s[8:11], s30 offen offset:1024 lds
  s_waitcnt lgkmcnt(0)
  s_waitcnt vmcnt(32)
  s_barrier
  ds_read_b128 v[0:3], v225 offset:32768
  ds_read_b64_tr_b16 v[8:9], v227 offset:32768
  ds_read_b64_tr_b16 v[10:11], v227 offset:33792
  ds_read_b128 v[4:7], v226 offset:32768
  ds_read_b64_tr_b16 v[12:13], v227 offset:36864
  ds_read_b64_tr_b16 v[14:15], v227 offset:37888
  v_mfma_f32_32x32x16_bf16 v[128:143], v[24:27], v[16:19], v[128:143]
  v_mfma_f32_32x32x16_bf16 v[128:143], v[28:31], v[20:23], v[128:143]
  s_lshl_b32 s29, s26, 11
  s_add_u32 m0, s29, 0x14000
  s_mov_b32 s30, 0x3c0
  buffer_load_dwordx4 v230, s[4:7], s30 offen lds
  buffer_load_dwordx4 v231, s[4:7], s30 offen offset:1024 lds
  s_add_u32 m0, s29, 0x16000
  s_mov_b32 s30, 0x3c0000
  buffer_load_dwordx4 v232, s[8:11], s30 offen lds
  buffer_load_dwordx4 v233, s[8:11], s30 offen offset:1024 lds
  s_waitcnt lgkmcnt(0)
  s_waitcnt vmcnt(32)
  s_barrier
  ds_read_b128 v[16:19], v225 offset:49152
  ds_read_b64_tr_b16 v[24:25], v227 offset:49152
  ds_read_b64_tr_b16 v[26:27], v227 offset:50176
  ds_read_b128 v[20:23], v226 offset:49152
  ds_read_b64_tr_b16 v[28:29], v227 offset:53248
  ds_read_b64_tr_b16 v[30:31], v227 offset:54272
  v_mfma_f32_32x32x16_bf16 v[128:143], v[8:11], v[0:3], v[128:143]
  v_mfma_f32_32x32x16_bf16 v[128:143], v[12:15], v[4:7], v[128:143]
  s_lshl_b32 s29, s26, 11
  s_add_u32 m0, s29, 0x18000
  s_mov_b32 s30, 0x400
  buffer_load_dwordx4 v230, s[4:7], s30 offen lds
  buffer_load_dwordx4 v231, s[4:7], s30 offen offset:1024 lds
  s_add_u32 m0, s29, 0x1a000
  s_mov_b32 s30, 0x400000
  buffer_load_dwordx4 v232, s[8:11], s30 offen lds
  buffer_load_dwordx4 v233, s[8:11], s30 offen offset:1024 lds
  s_waitcnt lgkmcnt(0)
  s_waitcnt vmcnt(32)
  s_barrier
  v_add_u32 v225, 0x10000, v225
  v_add_u32 v226, 0x10000, v226
  v_add_u32 v227, 0x10000, v227
  ds_read_b128 v[0:3], v225
  ds_read_b64_tr_b16 v[8:9], v227
  ds_read_b64_tr_b16 v[10:11], v227 offset:1024
  ds_read_b128 v[4:7], v226
  ds_read_b64_tr_b16 v[12:13], v227 offset:4096
  ds_read_b64_tr_b16 v[14:15], v227 offset:5120
  v_mfma_f32_32x32x16_bf16 v[128:143], v[24:27], v[16:19], v[128:143]
  v_mfma_f32_32x32x16_bf16 v[128:143], v[28:31], v[20:23], v[128:143]
  s_lshl_b32 s29, s26, 11
  s_add_u32 m0, s29, 0x1c000
  s_mov_b32 s30, 0x440
  buffer_load_dwordx4 v230, s[4:7], s30 offen lds
  buffer_load_dwordx4 v231, s[4:7], s30 offen offset:1024 lds
  s_add_u32 m0, s29, 0x1e000
  s_mov_b32 s30, 0x440000
  buffer_load_dwordx4 v232, s[8:11], s30 offen lds
  buffer_load_dwordx4 v233, s[8:11], s30 offen offset:1024 lds
  s_waitcnt lgkmcnt(0)
  s_waitcnt vmcnt(32)
  s_barrier
  ds_read_b128 v[16:19], v225 offset:16384
  ds_read_b64_tr_b16 v[24:25], v227 offset:16384
  ds_read_b64_tr_b16 v[26:27], v227 offset:17408
  ds_read_b128 v[20:23], v226 offset:16384
  ds_read_b64_tr_b16 v[28:29], v227 offset:20480
  ds_read_b64_tr_b16 v[30:31], v227 offset:21504
  v_mfma_f32_32x32x16_bf16 v[128:143], v[8:11], v[0:3], v[128:143]
  v_mfma_f32_32x32x16_bf16 v[128:143], v[12:15], v[4:7], v[128:143]
  s_lshl_b32 s29, s26, 11
  s_add_u32 m0, s29, 0x20000
  s_mov_b32 s30, 0x480
  buffer_load_dwordx4 v230, s[4:7], s30 offen lds
  buffer_load_dwordx4 v231, s[4:7], s30 offen offset:1024 lds
  s_add_u32 m0, s29, 0x22000
  s_mov_b32 s30, 0x480000
  buffer_load_dwordx4 v232, s[8:11], s30 offen lds
  buffer_load_dwordx4 v233, s[8:11], s30 offen offset:1024 lds
  s_waitcnt lgkmcnt(0)
  s_waitcnt vmcnt(32)
  s_barrier
  v_add_u32 v225, 0xfffe0000, v225
  v_add_u32 v226, 0xfffe0000, v226
  v_add_u32 v227, 0xfffe0000, v227
  ds_read_b128 v[0:3], v225
  ds_read_b64_tr_b16 v[8:9], v227
  ds_read_b64_tr_b16 v[10:11], v227 offset:1024
  ds_read_b128 v[4:7], v226
  ds_read_b64_tr_b16 v[12:13], v227 offset:4096
  ds_read_b64_tr_b16 v[14:15], v227 offset:5120
  v_mfma_f32_32x32x16_bf16 v[128:143], v[24:27], v[16:19], v[128:143]
  v_mfma_f32_32x32x16_bf16 v[128:143], v[28:31], v[20:23], v[128:143]
  s_lshl_b32 s29, s26, 11
  s_add_u32 m0, s29, 0x24000
  s_mov_b32 s30, 0x4c0
  buffer_load_dwordx4 v230, s[4:7], s30 offen lds
  buffer_load_dwordx4 v231, s[4:7], s30 offen offset:1024 lds
  s_add_u32 m0, s29, 0x26000
  s_mov_b32 s30, 0x4c0000
  buffer_load_dwordx4 v232, s[8:11], s30 offen lds
  buffer_load_dwordx4 v233, s[8:11], s30 offen offset:1024 lds
  s_waitcnt lgkmcnt(0)
  s_waitcnt vmcnt(32)
  s_barrier
  ds_read_b128 v[16:19], v225 offset:16384
  ds_read_b64_tr_b16 v[24:25], v227 offset:16384
  ds_read_b64_tr_b16 v[26:27], v227 offset:17408
  ds_read_b128 v[20:23], v226 offset:16384
  ds_read_b64_tr_b16 v[28:29], v227 offset:20480
  ds_read_b64_tr_b16 v[30:31], v227 offset:21504
  v_mfma_f32_32x32x16_bf16 v[128:143], v[8:11], v[0:3], v[128:143]
  v_mfma_f32_32x32x16_bf16 v[128:143], v[12:15], v[4:7], v[128:143]
  s_waitcnt lgkmcnt(0)
  s_waitcnt vmcnt(28)
  s_barrier
  ds_read_b128 v[0:3], v225 offset:32768
  ds_read_b64_tr_b16 v[8:9], v227 offset:32768
  ds_read_b64_tr_b16 v[10:11], v227 offset:33792
  ds_read_b128 v[4:7], v226 offset:32768
  ds_read_b64_tr_b16 v[12:13], v227 offset:36864
  ds_read_b64_tr_b16 v[14:15], v227 offset:37888
  v_mfma_f32_32x32x16_bf16 v[128:143], v[24:27], v[16:19], v[128:143]
  v_mfma_f32_32x32x16_bf16 v[128:143], v[28:31], v[20:23], v[128:143]
  s_waitcnt lgkmcnt(0)
  s_waitcnt vmcnt(24)
  s_barrier
  ds_read_b128 v[16:19], v225 offset:49152
  ds_read_b64_tr_b16 v[24:25], v227 offset:49152
  ds_read_b64_tr_b16 v[26:27], v227 offset:50176
  ds_read_b128 v[20:23], v226 offset:49152
  ds_read_b64_tr_b16 v[28:29], v227 offset:53248
  ds_read_b64_tr_b16 v[30:31], v227 offset:54272
  v_mfma_f32_32x32x16_bf16 v[128:143], v[8:11], v[0:3], v[128:143]
  v_mfma_f32_32x32x16_bf16 v[128:143], v[12:15], v[4:7], v[128:143]
  s_waitcnt lgkmcnt(0)
  s_waitcnt vmcnt(20)
  s_barrier
  v_add_u32 v225, 0x10000, v225
  v_add_u32 v226, 0x10000, v226
  v_add_u32 v227, 0x10000, v227
  ds_read_b128 v[0:3], v225
  ds_read_b64_tr_b16 v[8:9], v227
  ds_read_b64_tr_b16 v[10:11], v227 offset:1024
  ds_read_b128 v[4:7], v226
  ds_read_b64_tr_b16 v[12:13], v227 offset:4096
  ds_read_b64_tr_b16 v[14:15], v227 offset:5120
  v_mfma_f32_32x32x16_bf16 v[128:143], v[24:27], v[16:19], v[128:143]
  v_mfma_f32_32x32x16_bf16 v[128:143], v[28:31], v[20:23], v[128:143]
  s_waitcnt lgkmcnt(0)
  s_waitcnt vmcnt(16)
  s_barrier
  ds_read_b128 v[16:19], v225 offset:16384
  ds_read_b64_tr_b16 v[24:25], v227 offset:16384
  ds_read_b64_tr_b16 v[26:27], v227 offset:17408
  ds_read_b128 v[20:23], v226 offset:16384
  ds_read_b64_tr_b16 v[28:29], v227 offset:20480
  ds_read_b64_tr_b16 v[30:31], v227 offset:21504
  v_mfma_f32_32x32x16_bf16 v[128:143], v[8:11], v[0:3], v[128:143]
  v_mfma_f32_32x32x16_bf16 v[128:143], v[12:15], v[4:7], v[128:143]
  s_waitcnt lgkmcnt(0)
  s_waitcnt vmcnt(12)
  s_barrier
  ds_read_b128 v[0:3], v225 offset:32768
  ds_read_b64_tr_b16 v[8:9], v227 offset:32768
  ds_read_b64_tr_b16 v[10:11], v227 offset:33792
  ds_read_b128 v[4:7], v226 offset:32768
  ds_read_b64_tr_b16 v[12:13], v227 offset:36864
  ds_read_b64_tr_b16 v[14:15], v227 offset:37888
  v_mfma_f32_32x32x16_bf16 v[128:143], v[24:27], v[16:19], v[128:143]
  v_mfma_f32_32x32x16_bf16 v[128:143], v[28:31], v[20:23], v[128:143]
  s_waitcnt lgkmcnt(0)
  s_waitcnt vmcnt(8)
  s_barrier
  ds_read_b128 v[16:19], v225 offset:49152
  ds_read_b64_tr_b16 v[24:25], v227 offset:49152
  ds_read_b64_tr_b16 v[26:27], v227 offset:50176
  ds_read_b128 v[20:23], v226 offset:49152
  ds_read_b64_tr_b16 v[28:29], v227 offset:53248
  ds_read_b64_tr_b16 v[30:31], v227 offset:54272
  v_mfma_f32_32x32x16_bf16 v[128:143], v[8:11], v[0:3], v[128:143]
  v_mfma_f32_32x32x16_bf16 v[128:143], v[12:15], v[4:7], v[128:143]
  s_waitcnt lgkmcnt(0)
  s_waitcnt vmcnt(4)
  s_barrier
  v_add_u32 v225, 0x10000, v225
  v_add_u32 v226, 0x10000, v226
  v_add_u32 v227, 0x10000, v227
  ds_read_b128 v[0:3], v225
  ds_read_b64_tr_b16 v[8:9], v227
  ds_read_b64_tr_b16 v[10:11], v227 offset:1024
  ds_read_b128 v[4:7], v226
  ds_read_b64_tr_b16 v[12:13], v227 offset:4096
  ds_read_b64_tr_b16 v[14:15], v227 offset:5120
  v_mfma_f32_32x32x16_bf16 v[128:143], v[24:27], v[16:19], v[128:143]
  v_mfma_f32_32x32x16_bf16 v[128:143], v[28:31], v[20:23], v[128:143]
  s_waitcnt lgkmcnt(0)
  s_waitcnt vmcnt(0)
  s_barrier
  ds_read_b128 v[16:19], v225 offset:16384
  ds_read_b64_tr_b16 v[24:25], v227 offset:16384
  ds_read_b64_tr_b16 v[26:27], v227 offset:17408
  ds_read_b128 v[20:23], v226 offset:16384
  ds_read_b64_tr_b16 v[28:29], v227 offset:20480
  ds_read_b64_tr_b16 v[30:31], v227 offset:21504
  v_mfma_f32_32x32x16_bf16 v[128:143], v[8:11], v[0:3], v[128:143]
  v_mfma_f32_32x32x16_bf16 v[128:143], v[12:15], v[4:7], v[128:143]
  s_waitcnt lgkmcnt(0)
  v_mfma_f32_32x32x16_bf16 v[128:143], v[24:27], v[16:19], v[128:143]
  v_mfma_f32_32x32x16_bf16 v[128:143], v[28:31], v[20:23], v[128:143]
  s_lshl_b32 s29, s26, 13
  s_add_u32 s29, s29, 0x18000
  v_lshlrev_b32 v255, 4, v224
  v_add_u32 v255, s29, v255
  s_nop 7
  v_cvt_pk_bf16_f32 v0, v128, v129
  v_cvt_pk_bf16_f32 v1, v130, v131
  v_cvt_pk_bf16_f32 v2, v132, v133
  v_cvt_pk_bf16_f32 v3, v134, v135
  v_cvt_pk_bf16_f32 v4, v136, v137
  v_cvt_pk_bf16_f32 v5, v138, v139
  v_cvt_pk_bf16_f32 v6, v140, v141
  v_cvt_pk_bf16_f32 v7, v142, v143
  ds_write_b128 v255, v[0:3]
  ds_write_b128 v255, v[4:7] offset:1024
  s_waitcnt lgkmcnt(0)
  s_barrier
  ds_read_b128 v[160:163], v255
  ds_read_b128 v[164:167], v255 offset:1024
  ds_read_b128 v[168:171], v255 offset:2048
  ds_read_b128 v[172:175], v255 offset:3072
  ds_read_b128 v[176:179], v255 offset:4096
  ds_read_b128 v[180:183], v255 offset:5120
  ds_read_b128 v[184:187], v255 offset:6144
  ds_read_b128 v[188:191], v255 offset:7168
  s_waitcnt lgkmcnt(0)
  s_barrier
  s_barrier
  ds_read_b128 v[192:195], v235
  ds_read_b128 v[196:199], v236
  ds_read_b128 v[200:203], v237
  ds_read_b128 v[204:207], v238
  ds_read_b128 v[208:211], v239
  ds_read_b128 v[212:215], v240
  ds_read_b128 v[216:219], v241
  ds_read_b128 v[220:223], v242
  s_waitcnt lgkmcnt(0)
  s_barrier
  v_mfma_f32_32x32x16_bf16 v[0:15], v[192:195], v[160:163], 0
  ds_read_b128 v[192:195], v235 offset:16384
  v_mfma_f32_32x32x16_bf16 v[0:15], v[196:199], v[164:167], v[0:15]
  ds_read_b128 v[196:199], v236 offset:16384
  v_mfma_f32_32x32x16_bf16 v[0:15], v[200:203], v[168:171], v[0:15]
  ds_read_b128 v[200:203], v237 offset:16384
  v_mfma_f32_32x32x16_bf16 v[0:15], v[204:207], v[172:175], v[0:15]
  ds_read_b128 v[204:207], v238 offset:16384
  v_mfma_f32_32x32x16_bf16 v[0:15], v[208:211], v[176:179], v[0:15]
  ds_read_b128 v[208:211], v239 offset:16384
  v_mfma_f32_32x32x16_bf16 v[0:15], v[212:215], v[180:183], v[0:15]
  ds_read_b128 v[212:215], v240 offset:16384
  v_mfma_f32_32x32x16_bf16 v[0:15], v[216:219], v[184:187], v[0:15]
  ds_read_b128 v[216:219], v241 offset:16384
  v_mfma_f32_32x32x16_bf16 v[0:15], v[220:223], v[188:191], v[0:15]
  ds_read_b128 v[220:223], v242 offset:16384
  s_waitcnt lgkmcnt(0)
  s_barrier
  v_mfma_f32_32x32x16_bf16 v[16:31], v[192:195], v[160:163], 0
  ds_read_b128 v[192:195], v235 offset:32768
  s_nop 6
  v_max3_f32 v247, v0, v1, v2
  v_mfma_f32_32x32x16_bf16 v[16:31], v[196:199], v[164:167], v[16:31]
  ds_read_b128 v[196:199], v236 offset:32768
  v_max3_f32 v248, v3, v4, v5
  v_mfma_f32_32x32x16_bf16 v[16:31], v[200:203], v[168:171], v[16:31]
  ds_read_b128 v[200:203], v237 offset:32768
  v_max3_f32 v248, v248, v6, v7
  v_mfma_f32_32x32x16_bf16 v[16:31], v[204:207], v[172:175], v[16:31]
  ds_read_b128 v[204:207], v238 offset:32768
  v_max3_f32 v247, v247, v8, v9
  v_mfma_f32_32x32x16_bf16 v[16:31], v[208:211], v[176:179], v[16:31]
  ds_read_b128 v[208:211], v239 offset:32768
  v_max3_f32 v248, v248, v10, v11
  v_mfma_f32_32x32x16_bf16 v[16:31], v[212:215], v[180:183], v[16:31]
  ds_read_b128 v[212:215], v240 offset:32768
  v_max3_f32 v247, v247, v12, v13
  v_mfma_f32_32x32x16_bf16 v[16:31], v[216:219], v[184:187], v[16:31]
  ds_read_b128 v[216:219], v241 offset:32768
  v_max3_f32 v248, v248, v14, v15
  v_mfma_f32_32x32x16_bf16 v[16:31], v[220:223], v[188:191], v[16:31]
  ds_read_b128 v[220:223], v242 offset:32768
  s_waitcnt lgkmcnt(0)
  s_barrier
  v_mfma_f32_32x32x16_bf16 v[32:47], v[192:195], v[160:163], 0
  ds_read_b128 v[192:195], v235 offset:49152
  s_nop 6
  v_max3_f32 v247, v247, v16, v17
  v_mfma_f32_32x32x16_bf16 v[32:47], v[196:199], v[164:167], v[32:47]
  ds_read_b128 v[196:199], v236 offset:49152
  v_max3_f32 v248, v248, v18, v19
  v_mfma_f32_32x32x16_bf16 v[32:47], v[200:203], v[168:171], v[32:47]
  ds_read_b128 v[200:203], v237 offset:49152
  v_max3_f32 v247, v247, v20, v21
  v_mfma_f32_32x32x16_bf16 v[32:47], v[204:207], v[172:175], v[32:47]
  ds_read_b128 v[204:207], v238 offset:49152
  v_max3_f32 v248, v248, v22, v23
  v_mfma_f32_32x32x16_bf16 v[32:47], v[208:211], v[176:179], v[32:47]
  ds_read_b128 v[208:211], v239 offset:49152
  v_max3_f32 v247, v247, v24, v25
  v_mfma_f32_32x32x16_bf16 v[32:47], v[212:215], v[180:183], v[32:47]
  ds_read_b128 v[212:215], v240 offset:49152
  v_max3_f32 v248, v248, v26, v27
  v_mfma_f32_32x32x16_bf16 v[32:47], v[216:219], v[184:187], v[32:47]
  ds_read_b128 v[216:219], v241 offset:49152
  v_max3_f32 v247, v247, v28, v29
  v_mfma_f32_32x32x16_bf16 v[32:47], v[220:223], v[188:191], v[32:47]
  ds_read_b128 v[220:223], v242 offset:49152
  v_max3_f32 v248, v248, v30, v31
  s_waitcnt lgkmcnt(0)
  s_barrier
  v_add_u32 v235, 0x10000, v235
  v_add_u32 v236, 0x10000, v236
  v_add_u32 v237, 0x10000, v237
  v_add_u32 v238, 0x10000, v238
  v_add_u32 v239, 0x10000, v239
  v_add_u32 v240, 0x10000, v240
  v_add_u32 v241, 0x10000, v241
  v_add_u32 v242, 0x10000, v242
  v_mfma_f32_32x32x16_bf16 v[48:63], v[192:195], v[160:163], 0
  ds_read_b128 v[192:195], v235
  v_max3_f32 v247, v247, v32, v33
  v_mfma_f32_32x32x16_bf16 v[48:63], v[196:199], v[164:167], v[48:63]
  ds_read_b128 v[196:199], v236
  v_max3_f32 v248, v248, v34, v35
  v_mfma_f32_32x32x16_bf16 v[48:63], v[200:203], v[168:171], v[48:63]
  ds_read_b128 v[200:203], v237
  v_max3_f32 v247, v247, v36, v37
  v_mfma_f32_32x32x16_bf16 v[48:63], v[204:207], v[172:175], v[48:63]
  ds_read_b128 v[204:207], v238
  v_max3_f32 v248, v248, v38, v39
  v_mfma_f32_32x32x16_bf16 v[48:63], v[208:211], v[176:179], v[48:63]
  ds_read_b128 v[208:211], v239
  v_max3_f32 v247, v247, v40, v41
  v_mfma_f32_32x32x16_bf16 v[48:63], v[212:215], v[180:183], v[48:63]
  ds_read_b128 v[212:215], v240
  v_max3_f32 v248, v248, v42, v43
  v_mfma_f32_32x32x16_bf16 v[48:63], v[216:219], v[184:187], v[48:63]
  ds_read_b128 v[216:219], v241
  v_max3_f32 v247, v247, v44, v45
  v_mfma_f32_32x32x16_bf16 v[48:63], v[220:223], v[188:191], v[48:63]
  ds_read_b128 v[220:223], v242
  v_max3_f32 v248, v248, v46, v47
  s_waitcnt lgkmcnt(0)
  s_barrier
  v_mfma_f32_32x32x16_bf16 v[64:79], v[192:195], v[160:163], 0
  ds_read_b128 v[192:195], v235 offset:16384
  s_nop 5
  v_max3_f32 v247, v247, v48, v49
  v_mfma_f32_32x32x16_bf16 v[64:79], v[196:199], v[164:167], v[64:79]
  ds_read_b128 v[196:199], v236 offset:16384
  v_max3_f32 v248, v248, v50, v51
  v_mfma_f32_32x32x16_bf16 v[64:79], v[200:203], v[168:171], v[64:79]
  ds_read_b128 v[200:203], v237 offset:16384
  v_max3_f32 v247, v247, v52, v53
  v_mfma_f32_32x32x16_bf16 v[64:79], v[204:207], v[172:175], v[64:79]
  ds_read_b128 v[204:207], v238 offset:16384
  v_max3_f32 v248, v248, v54, v55
  v_mfma_f32_32x32x16_bf16 v[64:79], v[208:211], v[176:179], v[64:79]
  ds_read_b128 v[208:211], v239 offset:16384
  v_max3_f32 v247, v247, v56, v57
  v_mfma_f32_32x32x16_bf16 v[64:79], v[212:215], v[180:183], v[64:79]
  ds_read_b128 v[212:215], v240 offset:16384
  v_max3_f32 v248, v248, v58, v59
  v_mfma_f32_32x32x16_bf16 v[64:79], v[216:219], v[184:187], v[64:79]
  ds_read_b128 v[216:219], v241 offset:16384
  v_max3_f32 v247, v247, v60, v61
  v_mfma_f32_32x32x16_bf16 v[64:79], v[220:223], v[188:191], v[64:79]
  ds_read_b128 v[220:223], v242 offset:16384
  v_max3_f32 v248, v248, v62, v63
  s_waitcnt lgkmcnt(0)
  s_barrier
  v_add_u32 v235, 0x10000, v235
  v_add_u32 v236, 0x10000, v236
  v_add_u32 v237, 0x10000, v237
  v_add_u32 v238, 0x10000, v238
  v_add_u32 v239, 0x10000, v239
  v_add_u32 v240, 0x10000, v240
  v_add_u32 v241, 0x10000, v241
  v_add_u32 v242, 0x10000, v242
  v_mfma_f32_32x32x16_bf16 v[80:95], v[192:195], v[160:163], 0
  ds_read_b128 v[192:195], v235
  v_max3_f32 v247, v247, v64, v65
  v_mfma_f32_32x32x16_bf16 v[80:95], v[196:199], v[164:167], v[80:95]
  ds_read_b128 v[196:199], v236
  v_max3_f32 v248, v248, v66, v67
  v_mfma_f32_32x32x16_bf16 v[80:95], v[200:203], v[168:171], v[80:95]
  ds_read_b128 v[200:203], v237
  v_max3_f32 v247, v247, v68, v69
  v_mfma_f32_32x32x16_bf16 v[80:95], v[204:207], v[172:175], v[80:95]
  ds_read_b128 v[204:207], v238
  v_max3_f32 v248, v248, v70, v71
  v_mfma_f32_32x32x16_bf16 v[80:95], v[208:211], v[176:179], v[80:95]
  ds_read_b128 v[208:211], v239
  v_max3_f32 v247, v247, v72, v73
  v_mfma_f32_32x32x16_bf16 v[80:95], v[212:215], v[180:183], v[80:95]
  ds_read_b128 v[212:215], v240
  v_max3_f32 v248, v248, v74, v75
  v_mfma_f32_32x32x16_bf16 v[80:95], v[216:219], v[184:187], v[80:95]
  ds_read_b128 v[216:219], v241
  v_max3_f32 v247, v247, v76, v77
  v_mfma_f32_32x32x16_bf16 v[80:95], v[220:223], v[188:191], v[80:95]
  ds_read_b128 v[220:223], v242
  v_max3_f32 v248, v248, v78, v79
  s_waitcnt lgkmcnt(0)
  s_barrier
  v_mfma_f32_32x32x16_bf16 v[96:111], v[192:195], v[160:163], 0
  ds_read_b128 v[192:195], v235 offset:16384
  s_nop 5
  v_max3_f32 v247, v247, v80, v81
  v_mfma_f32_32x32x16_bf16 v[96:111], v[196:199], v[164:167], v[96:111]
  ds_read_b128 v[196:199], v236 offset:16384
  v_max3_f32 v248, v248, v82, v83
  v_mfma_f32_32x32x16_bf16 v[96:111], v[200:203], v[168:171], v[96:111]
  ds_read_b128 v[200:203], v237 offset:16384
  v_max3_f32 v247, v247, v84, v85
  v_mfma_f32_32x32x16_bf16 v[96:111], v[204:207], v[172:175], v[96:111]
  ds_read_b128 v[204:207], v238 offset:16384
  v_max3_f32 v248, v248, v86, v87
  v_mfma_f32_32x32x16_bf16 v[96:111], v[208:211], v[176:179], v[96:111]
  ds_read_b128 v[208:211], v239 offset:16384
  v_max3_f32 v247, v247, v88, v89
  v_mfma_f32_32x32x16_bf16 v[96:111], v[212:215], v[180:183], v[96:111]
  ds_read_b128 v[212:215], v240 offset:16384
  v_max3_f32 v248, v248, v90, v91
  v_mfma_f32_32x32x16_bf16 v[96:111], v[216:219], v[184:187], v[96:111]
  ds_read_b128 v[216:219], v241 offset:16384
  v_max3_f32 v247, v247, v92, v93
  v_mfma_f32_32x32x16_bf16 v[96:111], v[220:223], v[188:191], v[96:111]
  ds_read_b128 v[220:223], v242 offset:16384
  v_max3_f32 v248, v248, v94, v95
  s_waitcnt lgkmcnt(0)
  s_barrier
  v_add_u32 v243, 0x10000, v243
  v_add_u32 v244, 0x10000, v244
  v_add_u32 v245, 0x10000, v245
  v_add_u32 v246, 0x10000, v246
  v_mfma_f32_32x32x16_bf16 v[112:127], v[192:195], v[160:163], 0
  ds_read_b64_tr_b16 v[192:193], v243 offset:32768
  ds_read_b64_tr_b16 v[194:195], v243 offset:34816
  s_nop 0
  v_max3_f32 v247, v247, v96, v97
  v_mfma_f32_32x32x16_bf16 v[112:127], v[196:199], v[164:167], v[112:127]
  ds_read_b64_tr_b16 v[196:197], v244 offset:32768
  ds_read_b64_tr_b16 v[198:199], v244 offset:34816
  v_max3_f32 v248, v248, v98, v99
  v_mfma_f32_32x32x16_bf16 v[112:127], v[200:203], v[168:171], v[112:127]
  ds_read_b64_tr_b16 v[200:201], v245 offset:32768
  ds_read_b64_tr_b16 v[202:203], v245 offset:34816
  v_max3_f32 v247, v247, v100, v101
  v_mfma_f32_32x32x16_bf16 v[112:127], v[204:207], v[172:175], v[112:127]
  ds_read_b64_tr_b16 v[204:205], v246 offset:32768
  ds_read_b64_tr_b16 v[206:207], v246 offset:34816
  v_max3_f32 v248, v248, v102, v103
  v_mfma_f32_32x32x16_bf16 v[112:127], v[208:211], v[176:179], v[112:127]
  ds_read_b64_tr_b16 v[208:209], v243 offset:36864
  ds_read_b64_tr_b16 v[210:211], v243 offset:38912
  v_max3_f32 v247, v247, v104, v105
  v_mfma_f32_32x32x16_bf16 v[112:127], v[212:215], v[180:183], v[112:127]
  ds_read_b64_tr_b16 v[212:213], v244 offset:36864
  ds_read_b64_tr_b16 v[214:215], v244 offset:38912
  v_max3_f32 v248, v248, v106, v107
  v_mfma_f32_32x32x16_bf16 v[112:127], v[216:219], v[184:187], v[112:127]
  ds_read_b64_tr_b16 v[216:217], v245 offset:36864
  ds_read_b64_tr_b16 v[218:219], v245 offset:38912
  v_max3_f32 v247, v247, v108, v109
  v_mfma_f32_32x32x16_bf16 v[112:127], v[220:223], v[188:191], v[112:127]
  ds_read_b64_tr_b16 v[220:221], v246 offset:36864
  ds_read_b64_tr_b16 v[222:223], v246 offset:38912
  v_max3_f32 v248, v248, v110, v111
  s_nop 8
  v_max3_f32 v247, v247, v112, v113
  v_max3_f32 v248, v248, v114, v115
  v_max3_f32 v247, v247, v116, v117
  v_max3_f32 v248, v248, v118, v119
  v_max3_f32 v247, v247, v120, v121
  v_max3_f32 v248, v248, v122, v123
  v_max3_f32 v247, v247, v124, v125
  v_max3_f32 v248, v248, v126, v127
  v_max_f32 v247, v247, v248
  v_mov_b32 v250, v247
  s_nop 1
  v_permlane32_swap_b32 v247, v250
  v_max_f32 v247, v247, v250
  v_mul_f32 v249, s32, v247
  v_sub_f32 v249, 0, v249
  v_fma_f32 v0, v0, s32, v249
  v_fma_f32 v1, v1, s32, v249
  v_exp_f32 v0, v0
  v_exp_f32 v1, v1
  v_mov_b32 v248, v0
  v_mov_b32 v253, v1
  v_cvt_pk_bf16_f32 v0, v0, v1
  v_fma_f32 v2, v2, s32, v249
  v_fma_f32 v3, v3, s32, v249
  v_exp_f32 v2, v2
  v_exp_f32 v3, v3
  v_add_f32 v248, v248, v2
  v_add_f32 v253, v253, v3
  v_cvt_pk_bf16_f32 v1, v2, v3
  v_fma_f32 v4, v4, s32, v249
  v_fma_f32 v5, v5, s32, v249
  v_exp_f32 v4, v4
  v_exp_f32 v5, v5
  v_add_f32 v248, v248, v4
  v_add_f32 v253, v253, v5
  v_cvt_pk_bf16_f32 v2, v4, v5
  v_fma_f32 v6, v6, s32, v249
  v_fma_f32 v7, v7, s32, v249
  v_exp_f32 v6, v6
  v_exp_f32 v7, v7
  v_add_f32 v248, v248, v6
  v_add_f32 v253, v253, v7
  v_cvt_pk_bf16_f32 v3, v6, v7
  v_fma_f32 v8, v8, s32, v249
  v_fma_f32 v9, v9, s32, v249
  v_exp_f32 v8, v8
  v_exp_f32 v9, v9
  v_add_f32 v248, v248, v8
  v_add_f32 v253, v253, v9
  v_cvt_pk_bf16_f32 v4, v8, v9
  v_fma_f32 v10, v10, s32, v249
  v_fma_f32 v11, v11, s32, v249
  v_exp_f32 v10, v10
  v_exp_f32 v11, v11
  v_add_f32 v248, v248, v10
  v_add_f32 v253, v253, v11
  v_cvt_pk_bf16_f32 v5, v10, v11
  v_fma_f32 v12, v12, s32, v249
  v_fma_f32 v13, v13, s32, v249
  v_exp_f32 v12, v12
  v_exp_f32 v13, v13
  v_add_f32 v248, v248, v12
  v_add_f32 v253, v253, v13
  v_cvt_pk_bf16_f32 v6, v12, v13
  v_fma_f32 v14, v14, s32, v249
  v_fma_f32 v15, v15, s32, v249
  v_exp_f32 v14, v14
  v_exp_f32 v15, v15
  v_add_f32 v248, v248, v14
  v_add_f32 v253, v253, v15
  v_cvt_pk_bf16_f32 v7, v14, v15
  s_waitcnt lgkmcnt(0)
  s_barrier
  v_mfma_f32_32x32x16_bf16 v[128:143], v[192:195], v[0:3], 0
  ds_read_b64_tr_b16 v[192:193], v243 offset:49152
  ds_read_b64_tr_b16 v[194:195], v243 offset:51200
  v_fma_f32 v16, v16, s32, v249
  v_fma_f32 v17, v17, s32, v249
  v_exp_f32 v16, v16
  v_exp_f32 v17, v17
  v_add_f32 v248, v248, v16
  v_add_f32 v253, v253, v17
  v_cvt_pk_bf16_f32 v16, v16, v17
  v_mfma_f32_32x32x16_bf16 v[144:159], v[196:199], v[0:3], 0
  ds_read_b64_tr_b16 v[196:197], v244 offset:49152
  ds_read_b64_tr_b16 v[198:199], v244 offset:51200
  v_fma_f32 v18, v18, s32, v249
  v_fma_f32 v19, v19, s32, v249
  v_exp_f32 v18, v18
  v_exp_f32 v19, v19
  v_add_f32 v248, v248, v18
  v_add_f32 v253, v253, v19
  v_cvt_pk_bf16_f32 v17, v18, v19
  v_mfma_f32_32x32x16_bf16 v[160:175], v[200:203], v[0:3], 0
  ds_read_b64_tr_b16 v[200:201], v245 offset:49152
  ds_read_b64_tr_b16 v[202:203], v245 offset:51200
  v_fma_f32 v20, v20, s32, v249
  v_fma_f32 v21, v21, s32, v249
  v_exp_f32 v20, v20
  v_exp_f32 v21, v21
  v_add_f32 v248, v248, v20
  v_add_f32 v253, v253, v21
  v_cvt_pk_bf16_f32 v18, v20, v21
  v_mfma_f32_32x32x16_bf16 v[176:191], v[204:207], v[0:3], 0
  ds_read_b64_tr_b16 v[204:205], v246 offset:49152
  ds_read_b64_tr_b16 v[206:207], v246 offset:51200
  v_fma_f32 v22, v22, s32, v249
  v_fma_f32 v23, v23, s32, v249
  v_exp_f32 v22, v22
  v_exp_f32 v23, v23
  v_add_f32 v248, v248, v22
  v_add_f32 v253, v253, v23
  v_cvt_pk_bf16_f32 v19, v22, v23
  v_mfma_f32_32x32x16_bf16 v[128:143], v[208:211], v[4:7], v[128:143]
  ds_read_b64_tr_b16 v[208:209], v243 offset:53248
  ds_read_b64_tr_b16 v[210:211], v243 offset:55296
  v_fma_f32 v24, v24, s32, v249
  v_fma_f32 v25, v25, s32, v249
  v_exp_f32 v24, v24
  v_exp_f32 v25, v25
  v_add_f32 v248, v248, v24
  v_add_f32 v253, v253, v25
  v_cvt_pk_bf16_f32 v20, v24, v25
  v_mfma_f32_32x32x16_bf16 v[144:159], v[212:215], v[4:7], v[144:159]
  ds_read_b64_tr_b16 v[212:213], v244 offset:53248
  ds_read_b64_tr_b16 v[214:215], v244 offset:55296
  v_fma_f32 v26, v26, s32, v249
  v_fma_f32 v27, v27, s32, v249
  v_exp_f32 v26, v26
  v_exp_f32 v27, v27
  v_add_f32 v248, v248, v26
  v_add_f32 v253, v253, v27
  v_cvt_pk_bf16_f32 v21, v26, v27
  v_mfma_f32_32x32x16_bf16 v[160:175], v[216:219], v[4:7], v[160:175]
  ds_read_b64_tr_b16 v[216:217], v245 offset:53248
  ds_read_b64_tr_b16 v[218:219], v245 offset:55296
  v_fma_f32 v28, v28, s32, v249
  v_fma_f32 v29, v29, s32, v249
  v_exp_f32 v28, v28
  v_exp_f32 v29, v29
  v_add_f32 v248, v248, v28
  v_add_f32 v253, v253, v29
  v_cvt_pk_bf16_f32 v22, v28, v29
  v_mfma_f32_32x32x16_bf16 v[176:191], v[220:223], v[4:7], v[176:191]
  ds_read_b64_tr_b16 v[220:221], v246 offset:53248
  ds_read_b64_tr_b16 v[222:223], v246 offset:55296
  v_fma_f32 v30, v30, s32, v249
  v_fma_f32 v31, v31, s32, v249
  v_exp_f32 v30, v30
  v_exp_f32 v31, v31
  v_add_f32 v248, v248, v30
  v_add_f32 v253, v253, v31
  v_cvt_pk_bf16_f32 v23, v30, v31
  s_waitcnt lgkmcnt(0)
  s_barrier
  v_add_u32 v243, 0xffff0000, v243
  v_add_u32 v244, 0xffff0000, v244
  v_add_u32 v245, 0xffff0000, v245
  v_add_u32 v246, 0xffff0000, v246
  v_mfma_f32_32x32x16_bf16 v[128:143], v[192:195], v[16:19], v[128:143]
  ds_read_b64_tr_b16 v[192:193], v243
  ds_read_b64_tr_b16 v[194:195], v243 offset:2048
  v_fma_f32 v32, v32, s32, v249
  v_fma_f32 v33, v33, s32, v249
  v_exp_f32 v32, v32
  v_exp_f32 v33, v33
  v_add_f32 v248, v248, v32
  v_add_f32 v253, v253, v33
  v_cvt_pk_bf16_f32 v32, v32, v33
  v_mfma_f32_32x32x16_bf16 v[144:159], v[196:199], v[16:19], v[144:159]
  ds_read_b64_tr_b16 v[196:197], v244
  ds_read_b64_tr_b16 v[198:199], v244 offset:2048
  v_fma_f32 v34, v34, s32, v249
  v_fma_f32 v35, v35, s32, v249
  v_exp_f32 v34, v34
  v_exp_f32 v35, v35
  v_add_f32 v248, v248, v34
  v_add_f32 v253, v253, v35
  v_cvt_pk_bf16_f32 v33, v34, v35
  v_mfma_f32_32x32x16_bf16 v[160:175], v[200:203], v[16:19], v[160:175]
  ds_read_b64_tr_b16 v[200:201], v245
  ds_read_b64_tr_b16 v[202:203], v245 offset:2048
  v_fma_f32 v36, v36, s32, v249
  v_fma_f32 v37, v37, s32, v249
  v_exp_f32 v36, v36
  v_exp_f32 v37, v37
  v_add_f32 v248, v248, v36
  v_add_f32 v253, v253, v37
  v_cvt_pk_bf16_f32 v34, v36, v37
  v_mfma_f32_32x32x16_bf16 v[176:191], v[204:207], v[16:19], v[176:191]
  ds_read_b64_tr_b16 v[204:205], v246
  ds_read_b64_tr_b16 v[206:207], v246 offset:2048
  v_fma_f32 v38, v38, s32, v249
  v_fma_f32 v39, v39, s32, v249
  v_exp_f32 v38, v38
  v_exp_f32 v39, v39
  v_add_f32 v248, v248, v38
  v_add_f32 v253, v253, v39
  v_cvt_pk_bf16_f32 v35, v38, v39
  v_mfma_f32_32x32x16_bf16 v[128:143], v[208:211], v[20:23], v[128:143]
  ds_read_b64_tr_b16 v[208:209], v243 offset:4096
  ds_read_b64_tr_b16 v[210:211], v243 offset:6144
  v_fma_f32 v40, v40, s32, v249
  v_fma_f32 v41, v41, s32, v249
  v_exp_f32 v40, v40
  v_exp_f32 v41, v41
  v_add_f32 v248, v248, v40
  v_add_f32 v253, v253, v41
  v_cvt_pk_bf16_f32 v36, v40, v41
  v_mfma_f32_32x32x16_bf16 v[144:159], v[212:215], v[20:23], v[144:159]
  ds_read_b64_tr_b16 v[212:213], v244 offset:4096
  ds_read_b64_tr_b16 v[214:215], v244 offset:6144
  v_fma_f32 v42, v42, s32, v249
  v_fma_f32 v43, v43, s32, v249
  v_exp_f32 v42, v42
  v_exp_f32 v43, v43
  v_add_f32 v248, v248, v42
  v_add_f32 v253, v253, v43
  v_cvt_pk_bf16_f32 v37, v42, v43
  v_mfma_f32_32x32x16_bf16 v[160:175], v[216:219], v[20:23], v[160:175]
  ds_read_b64_tr_b16 v[216:217], v245 offset:4096
  ds_read_b64_tr_b16 v[218:219], v245 offset:6144
  v_fma_f32 v44, v44, s32, v249
  v_fma_f32 v45, v45, s32, v249
  v_exp_f32 v44, v44
  v_exp_f32 v45, v45
  v_add_f32 v248, v248, v44
  v_add_f32 v253, v253, v45
  v_cvt_pk_bf16_f32 v38, v44, v45
  v_mfma_f32_32x32x16_bf16 v[176:191], v[220:223], v[20:23], v[176:191]
  ds_read_b64_tr_b16 v[220:221], v246 offset:4096
  ds_read_b64_tr_b16 v[222:223], v246 offset:6144
  v_fma_f32 v46, v46, s32, v249
  v_fma_f32 v47, v47, s32, v249
  v_exp_f32 v46, v46
  v_exp_f32 v47, v47
  v_add_f32 v248, v248, v46
  v_add_f32 v253, v253, v47
  v_cvt_pk_bf16_f32 v39, v46, v47
  s_waitcnt lgkmcnt(0)
  s_barrier
  v_mfma_f32_32x32x16_bf16 v[128:143], v[192:195], v[32:35], v[128:143]
  ds_read_b64_tr_b16 v[192:193], v243 offset:16384
  ds_read_b64_tr_b16 v[194:195], v243 offset:18432
  v_fma_f32 v48, v48, s32, v249
  v_fma_f32 v49, v49, s32, v249
  v_exp_f32 v48, v48
  v_exp_f32 v49, v49
  v_add_f32 v248, v248, v48
  v_add_f32 v253, v253, v49
  v_cvt_pk_bf16_f32 v48, v48, v49
  v_mfma_f32_32x32x16_bf16 v[144:159], v[196:199], v[32:35], v[144:159]
  ds_read_b64_tr_b16 v[196:197], v244 offset:16384
  ds_read_b64_tr_b16 v[198:199], v244 offset:18432
  v_fma_f32 v50, v50, s32, v249
  v_fma_f32 v51, v51, s32, v249
  v_exp_f32 v50, v50
  v_exp_f32 v51, v51
  v_add_f32 v248, v248, v50
  v_add_f32 v253, v253, v51
  v_cvt_pk_bf16_f32 v49, v50, v51
  v_mfma_f32_32x32x16_bf16 v[160:175], v[200:203], v[32:35], v[160:175]
  ds_read_b64_tr_b16 v[200:201], v245 offset:16384
  ds_read_b64_tr_b16 v[202:203], v245 offset:18432
  v_fma_f32 v52, v52, s32, v249
  v_fma_f32 v53, v53, s32, v249
  v_exp_f32 v52, v52
  v_exp_f32 v53, v53
  v_add_f32 v248, v248, v52
  v_add_f32 v253, v253, v53
  v_cvt_pk_bf16_f32 v50, v52, v53
  v_mfma_f32_32x32x16_bf16 v[176:191], v[204:207], v[32:35], v[176:191]
  ds_read_b64_tr_b16 v[204:205], v246 offset:16384
  ds_read_b64_tr_b16 v[206:207], v246 offset:18432
  v_fma_f32 v54, v54, s32, v249
  v_fma_f32 v55, v55, s32, v249
  v_exp_f32 v54, v54
  v_exp_f32 v55, v55
  v_add_f32 v248, v248, v54
  v_add_f32 v253, v253, v55
  v_cvt_pk_bf16_f32 v51, v54, v55
  v_mfma_f32_32x32x16_bf16 v[128:143], v[208:211], v[36:39], v[128:143]
  ds_read_b64_tr_b16 v[208:209], v243 offset:20480
  ds_read_b64_tr_b16 v[210:211], v243 offset:22528
  v_fma_f32 v56, v56, s32, v249
  v_fma_f32 v57, v57, s32, v249
  v_exp_f32 v56, v56
  v_exp_f32 v57, v57
  v_add_f32 v248, v248, v56
  v_add_f32 v253, v253, v57
  v_cvt_pk_bf16_f32 v52, v56, v57
  v_mfma_f32_32x32x16_bf16 v[144:159], v[212:215], v[36:39], v[144:159]
  ds_read_b64_tr_b16 v[212:213], v244 offset:20480
  ds_read_b64_tr_b16 v[214:215], v244 offset:22528
  v_fma_f32 v58, v58, s32, v249
  v_fma_f32 v59, v59, s32, v249
  v_exp_f32 v58, v58
  v_exp_f32 v59, v59
  v_add_f32 v248, v248, v58
  v_add_f32 v253, v253, v59
  v_cvt_pk_bf16_f32 v53, v58, v59
  v_mfma_f32_32x32x16_bf16 v[160:175], v[216:219], v[36:39], v[160:175]
  ds_read_b64_tr_b16 v[216:217], v245 offset:20480
  ds_read_b64_tr_b16 v[218:219], v245 offset:22528
  v_fma_f32 v60, v60, s32, v249
  v_fma_f32 v61, v61, s32, v249
  v_exp_f32 v60, v60
  v_exp_f32 v61, v61
  v_add_f32 v248, v248, v60
  v_add_f32 v253, v253, v61
  v_cvt_pk_bf16_f32 v54, v60, v61
  v_mfma_f32_32x32x16_bf16 v[176:191], v[220:223], v[36:39], v[176:191]
  ds_read_b64_tr_b16 v[220:221], v246 offset:20480
  ds_read_b64_tr_b16 v[222:223], v246 offset:22528
  v_fma_f32 v62, v62, s32, v249
  v_fma_f32 v63, v63, s32, v249
  v_exp_f32 v62, v62
  v_exp_f32 v63, v63
  v_add_f32 v248, v248, v62
  v_add_f32 v253, v253, v63
  v_cvt_pk_bf16_f32 v55, v62, v63
  s_waitcnt lgkmcnt(0)
  s_barrier
  v_mfma_f32_32x32x16_bf16 v[128:143], v[192:195], v[48:51], v[128:143]
  ds_read_b64_tr_b16 v[192:193], v243 offset:32768
  ds_read_b64_tr_b16 v[194:195], v243 offset:34816
  v_fma_f32 v64, v64, s32, v249
  v_fma_f32 v65, v65, s32, v249
  v_exp_f32 v64, v64
  v_exp_f32 v65, v65
  v_add_f32 v248, v248, v64
  v_add_f32 v253, v253, v65
  v_cvt_pk_bf16_f32 v64, v64, v65
  v_mfma_f32_32x32x16_bf16 v[144:159], v[196:199], v[48:51], v[144:159]
  ds_read_b64_tr_b16 v[196:197], v244 offset:32768
  ds_read_b64_tr_b16 v[198:199], v244 offset:34816
  v_fma_f32 v66, v66, s32, v249
  v_fma_f32 v67, v67, s32, v249
  v_exp_f32 v66, v66
  v_exp_f32 v67, v67
  v_add_f32 v248, v248, v66
  v_add_f32 v253, v253, v67
  v_cvt_pk_bf16_f32 v65, v66, v67
  v_mfma_f32_32x32x16_bf16 v[160:175], v[200:203], v[48:51], v[160:175]
  ds_read_b64_tr_b16 v[200:201], v245 offset:32768
  ds_read_b64_tr_b16 v[202:203], v245 offset:34816
  v_fma_f32 v68, v68, s32, v249
  v_fma_f32 v69, v69, s32, v249
  v_exp_f32 v68, v68
  v_exp_f32 v69, v69
  v_add_f32 v248, v248, v68
  v_add_f32 v253, v253, v69
  v_cvt_pk_bf16_f32 v66, v68, v69
  v_mfma_f32_32x32x16_bf16 v[176:191], v[204:207], v[48:51], v[176:191]
  ds_read_b64_tr_b16 v[204:205], v246 offset:32768
  ds_read_b64_tr_b16 v[206:207], v246 offset:34816
  v_fma_f32 v70, v70, s32, v249
  v_fma_f32 v71, v71, s32, v249
  v_exp_f32 v70, v70
  v_exp_f32 v71, v71
  v_add_f32 v248, v248, v70
  v_add_f32 v253, v253, v71
  v_cvt_pk_bf16_f32 v67, v70, v71
  v_mfma_f32_32x32x16_bf16 v[128:143], v[208:211], v[52:55], v[128:143]
  ds_read_b64_tr_b16 v[208:209], v243 offset:36864
  ds_read_b64_tr_b16 v[210:211], v243 offset:38912
  v_fma_f32 v72, v72, s32, v249
  v_fma_f32 v73, v73, s32, v249
  v_exp_f32 v72, v72
  v_exp_f32 v73, v73
  v_add_f32 v248, v248, v72
  v_add_f32 v253, v253, v73
  v_cvt_pk_bf16_f32 v68, v72, v73
  v_mfma_f32_32x32x16_bf16 v[144:159], v[212:215], v[52:55], v[144:159]
  ds_read_b64_tr_b16 v[212:213], v244 offset:36864
  ds_read_b64_tr_b16 v[214:215], v244 offset:38912
  v_fma_f32 v74, v74, s32, v249
  v_fma_f32 v75, v75, s32, v249
  v_exp_f32 v74, v74
  v_exp_f32 v75, v75
  v_add_f32 v248, v248, v74
  v_add_f32 v253, v253, v75
  v_cvt_pk_bf16_f32 v69, v74, v75
  v_mfma_f32_32x32x16_bf16 v[160:175], v[216:219], v[52:55], v[160:175]
  ds_read_b64_tr_b16 v[216:217], v245 offset:36864
  ds_read_b64_tr_b16 v[218:219], v245 offset:38912
  v_fma_f32 v76, v76, s32, v249
  v_fma_f32 v77, v77, s32, v249
  v_exp_f32 v76, v76
  v_exp_f32 v77, v77
  v_add_f32 v248, v248, v76
  v_add_f32 v253, v253, v77
  v_cvt_pk_bf16_f32 v70, v76, v77
  v_mfma_f32_32x32x16_bf16 v[176:191], v[220:223], v[52:55], v[176:191]
  ds_read_b64_tr_b16 v[220:221], v246 offset:36864
  ds_read_b64_tr_b16 v[222:223], v246 offset:38912
  v_fma_f32 v78, v78, s32, v249
  v_fma_f32 v79, v79, s32, v249
  v_exp_f32 v78, v78
  v_exp_f32 v79, v79
  v_add_f32 v248, v248, v78
  v_add_f32 v253, v253, v79
  v_cvt_pk_bf16_f32 v71, v78, v79
  s_waitcnt lgkmcnt(0)
  s_barrier
  v_mfma_f32_32x32x16_bf16 v[128:143], v[192:195], v[64:67], v[128:143]
  ds_read_b64_tr_b16 v[192:193], v243 offset:49152
  ds_read_b64_tr_b16 v[194:195], v243 offset:51200
  v_fma_f32 v80, v80, s32, v249
  v_fma_f32 v81, v81, s32, v249
  v_exp_f32 v80, v80
  v_exp_f32 v81, v81
  v_add_f32 v248, v248, v80
  v_add_f32 v253, v253, v81
  v_cvt_pk_bf16_f32 v80, v80, v81
  v_mfma_f32_32x32x16_bf16 v[144:159], v[196:199], v[64:67], v[144:159]
  ds_read_b64_tr_b16 v[196:197], v244 offset:49152
  ds_read_b64_tr_b16 v[198:199], v244 offset:51200
  v_fma_f32 v82, v82, s32, v249
  v_fma_f32 v83, v83, s32, v249
  v_exp_f32 v82, v82
  v_exp_f32 v83, v83
  v_add_f32 v248, v248, v82
  v_add_f32 v253, v253, v83
  v_cvt_pk_bf16_f32 v81, v82, v83
  v_mfma_f32_32x32x16_bf16 v[160:175], v[200:203], v[64:67], v[160:175]
  ds_read_b64_tr_b16 v[200:201], v245 offset:49152
  ds_read_b64_tr_b16 v[202:203], v245 offset:51200
  v_fma_f32 v84, v84, s32, v249
  v_fma_f32 v85, v85, s32, v249
  v_exp_f32 v84, v84
  v_exp_f32 v85, v85
  v_add_f32 v248, v248, v84
  v_add_f32 v253, v253, v85
  v_cvt_pk_bf16_f32 v82, v84, v85
  v_mfma_f32_32x32x16_bf16 v[176:191], v[204:207], v[64:67], v[176:191]
  ds_read_b64_tr_b16 v[204:205], v246 offset:49152
  ds_read_b64_tr_b16 v[206:207], v246 offset:51200
  v_fma_f32 v86, v86, s32, v249
  v_fma_f32 v87, v87, s32, v249
  v_exp_f32 v86, v86
  v_exp_f32 v87, v87
  v_add_f32 v248, v248, v86
  v_add_f32 v253, v253, v87
  v_cvt_pk_bf16_f32 v83, v86, v87
  v_mfma_f32_32x32x16_bf16 v[128:143], v[208:211], v[68:71], v[128:143]
  ds_read_b64_tr_b16 v[208:209], v243 offset:53248
  ds_read_b64_tr_b16 v[210:211], v243 offset:55296
  v_fma_f32 v88, v88, s32, v249
  v_fma_f32 v89, v89, s32, v249
  v_exp_f32 v88, v88
  v_exp_f32 v89, v89
  v_add_f32 v248, v248, v88
  v_add_f32 v253, v253, v89
  v_cvt_pk_bf16_f32 v84, v88, v89
  v_mfma_f32_32x32x16_bf16 v[144:159], v[212:215], v[68:71], v[144:159]
  ds_read_b64_tr_b16 v[212:213], v244 offset:53248
  ds_read_b64_tr_b16 v[214:215], v244 offset:55296
  v_fma_f32 v90, v90, s32, v249
  v_fma_f32 v91, v91, s32, v249
  v_exp_f32 v90, v90
  v_exp_f32 v91, v91
  v_add_f32 v248, v248, v90
  v_add_f32 v253, v253, v91
  v_cvt_pk_bf16_f32 v85, v90, v91
  v_mfma_f32_32x32x16_bf16 v[160:175], v[216:219], v[68:71], v[160:175]
  ds_read_b64_tr_b16 v[216:217], v245 offset:53248
  ds_read_b64_tr_b16 v[218:219], v245 offset:55296
  v_fma_f32 v92, v92, s32, v249
  v_fma_f32 v93, v93, s32, v249
  v_exp_f32 v92, v92
  v_exp_f32 v93, v93
  v_add_f32 v248, v248, v92
  v_add_f32 v253, v253, v93
  v_cvt_pk_bf16_f32 v86, v92, v93
  v_mfma_f32_32x32x16_bf16 v[176:191], v[220:223], v[68:71], v[176:191]
  ds_read_b64_tr_b16 v[220:221], v246 offset:53248
  ds_read_b64_tr_b16 v[222:223], v246 offset:55296
  v_fma_f32 v94, v94, s32, v249
  v_fma_f32 v95, v95, s32, v249
  v_exp_f32 v94, v94
  v_exp_f32 v95, v95
  v_add_f32 v248, v248, v94
  v_add_f32 v253, v253, v95
  v_cvt_pk_bf16_f32 v87, v94, v95
  s_waitcnt lgkmcnt(0)
  s_barrier
  v_add_u32 v243, 0x10000, v243
  v_add_u32 v244, 0x10000, v244
  v_add_u32 v245, 0x10000, v245
  v_add_u32 v246, 0x10000, v246
  v_mfma_f32_32x32x16_bf16 v[128:143], v[192:195], v[80:83], v[128:143]
  ds_read_b64_tr_b16 v[192:193], v243
  ds_read_b64_tr_b16 v[194:195], v243 offset:2048
  v_fma_f32 v96, v96, s32, v249
  v_fma_f32 v97, v97, s32, v249
  v_exp_f32 v96, v96
  v_exp_f32 v97, v97
  v_add_f32 v248, v248, v96
  v_add_f32 v253, v253, v97
  v_cvt_pk_bf16_f32 v96, v96, v97
  v_mfma_f32_32x32x16_bf16 v[144:159], v[196:199], v[80:83], v[144:159]
  ds_read_b64_tr_b16 v[196:197], v244
  ds_read_b64_tr_b16 v[198:199], v244 offset:2048
  v_fma_f32 v98, v98, s32, v249
  v_fma_f32 v99, v99, s32, v249
  v_exp_f32 v98, v98
  v_exp_f32 v99, v99
  v_add_f32 v248, v248, v98
  v_add_f32 v253, v253, v99
  v_cvt_pk_bf16_f32 v97, v98, v99
  v_mfma_f32_32x32x16_bf16 v[160:175], v[200:203], v[80:83], v[160:175]
  ds_read_b64_tr_b16 v[200:201], v245
  ds_read_b64_tr_b16 v[202:203], v245 offset:2048
  v_fma_f32 v100, v100, s32, v249
  v_fma_f32 v101, v101, s32, v249
  v_exp_f32 v100, v100
  v_exp_f32 v101, v101
  v_add_f32 v248, v248, v100
  v_add_f32 v253, v253, v101
  v_cvt_pk_bf16_f32 v98, v100, v101
  v_mfma_f32_32x32x16_bf16 v[176:191], v[204:207], v[80:83], v[176:191]
  ds_read_b64_tr_b16 v[204:205], v246
  ds_read_b64_tr_b16 v[206:207], v246 offset:2048
  v_fma_f32 v102, v102, s32, v249
  v_fma_f32 v103, v103, s32, v249
  v_exp_f32 v102, v102
  v_exp_f32 v103, v103
  v_add_f32 v248, v248, v102
  v_add_f32 v253, v253, v103
  v_cvt_pk_bf16_f32 v99, v102, v103
  v_mfma_f32_32x32x16_bf16 v[128:143], v[208:211], v[84:87], v[128:143]
  ds_read_b64_tr_b16 v[208:209], v243 offset:4096
  ds_read_b64_tr_b16 v[210:211], v243 offset:6144
  v_fma_f32 v104, v104, s32, v249
  v_fma_f32 v105, v105, s32, v249
  v_exp_f32 v104, v104
  v_exp_f32 v105, v105
  v_add_f32 v248, v248, v104
  v_add_f32 v253, v253, v105
  v_cvt_pk_bf16_f32 v100, v104, v105
  v_mfma_f32_32x32x16_bf16 v[144:159], v[212:215], v[84:87], v[144:159]
  ds_read_b64_tr_b16 v[212:213], v244 offset:4096
  ds_read_b64_tr_b16 v[214:215], v244 offset:6144
  v_fma_f32 v106, v106, s32, v249
  v_fma_f32 v107, v107, s32, v249
  v_exp_f32 v106, v106
  v_exp_f32 v107, v107
  v_add_f32 v248, v248, v106
  v_add_f32 v253, v253, v107
  v_cvt_pk_bf16_f32 v101, v106, v107
  v_mfma_f32_32x32x16_bf16 v[160:175], v[216:219], v[84:87], v[160:175]
  ds_read_b64_tr_b16 v[216:217], v245 offset:4096
  ds_read_b64_tr_b16 v[218:219], v245 offset:6144
  v_fma_f32 v108, v108, s32, v249
  v_fma_f32 v109, v109, s32, v249
  v_exp_f32 v108, v108
  v_exp_f32 v109, v109
  v_add_f32 v248, v248, v108
  v_add_f32 v253, v253, v109
  v_cvt_pk_bf16_f32 v102, v108, v109
  v_mfma_f32_32x32x16_bf16 v[176:191], v[220:223], v[84:87], v[176:191]
  ds_read_b64_tr_b16 v[220:221], v246 offset:4096
  ds_read_b64_tr_b16 v[222:223], v246 offset:6144
  v_fma_f32 v110, v110, s32, v249
  v_fma_f32 v111, v111, s32, v249
  v_exp_f32 v110, v110
  v_exp_f32 v111, v111
  v_add_f32 v248, v248, v110
  v_add_f32 v253, v253, v111
  v_cvt_pk_bf16_f32 v103, v110, v111
  s_waitcnt lgkmcnt(0)
  s_barrier
  v_mfma_f32_32x32x16_bf16 v[128:143], v[192:195], v[96:99], v[128:143]
  ds_read_b64_tr_b16 v[192:193], v243 offset:16384
  ds_read_b64_tr_b16 v[194:195], v243 offset:18432
  v_fma_f32 v112, v112, s32, v249
  v_fma_f32 v113, v113, s32, v249
  v_exp_f32 v112, v112
  v_exp_f32 v113, v113
  v_add_f32 v248, v248, v112
  v_add_f32 v253, v253, v113
  v_cvt_pk_bf16_f32 v112, v112, v113
  v_fma_f32 v114, v114, s32, v249
  v_mfma_f32_32x32x16_bf16 v[144:159], v[196:199], v[96:99], v[144:159]
  ds_read_b64_tr_b16 v[196:197], v244 offset:16384
  ds_read_b64_tr_b16 v[198:199], v244 offset:18432
  v_fma_f32 v115, v115, s32, v249
  v_exp_f32 v114, v114
  v_exp_f32 v115, v115
  v_add_f32 v248, v248, v114
  v_add_f32 v253, v253, v115
  v_cvt_pk_bf16_f32 v113, v114, v115
  v_fma_f32 v116, v116, s32, v249
  v_fma_f32 v117, v117, s32, v249
  v_mfma_f32_32x32x16_bf16 v[160:175], v[200:203], v[96:99], v[160:175]
  ds_read_b64_tr_b16 v[200:201], v245 offset:16384
  ds_read_b64_tr_b16 v[202:203], v245 offset:18432
  v_exp_f32 v116, v116
  v_exp_f32 v117, v117
  v_add_f32 v248, v248, v116
  v_add_f32 v253, v253, v117
  v_cvt_pk_bf16_f32 v114, v116, v117
  v_fma_f32 v118, v118, s32, v249
  v_fma_f32 v119, v119, s32, v249
  v_exp_f32 v118, v118
  v_mfma_f32_32x32x16_bf16 v[176:191], v[204:207], v[96:99], v[176:191]
  ds_read_b64_tr_b16 v[204:205], v246 offset:16384
  ds_read_b64_tr_b16 v[206:207], v246 offset:18432
  v_exp_f32 v119, v119
  v_add_f32 v248, v248, v118
  v_add_f32 v253, v253, v119
  v_cvt_pk_bf16_f32 v115, v118, v119
  v_fma_f32 v120, v120, s32, v249
  v_fma_f32 v121, v121, s32, v249
  v_exp_f32 v120, v120
  v_exp_f32 v121, v121
  v_mfma_f32_32x32x16_bf16 v[128:143], v[208:211], v[100:103], v[128:143]
  ds_read_b64_tr_b16 v[208:209], v243 offset:20480
  ds_read_b64_tr_b16 v[210:211], v243 offset:22528
  v_add_f32 v248, v248, v120
  v_add_f32 v253, v253, v121
  v_cvt_pk_bf16_f32 v116, v120, v121
  v_fma_f32 v122, v122, s32, v249
  v_fma_f32 v123, v123, s32, v249
  v_exp_f32 v122, v122
  v_exp_f32 v123, v123
  v_add_f32 v248, v248, v122
  v_mfma_f32_32x32x16_bf16 v[144:159], v[212:215], v[100:103], v[144:159]
  ds_read_b64_tr_b16 v[212:213], v244 offset:20480
  ds_read_b64_tr_b16 v[214:215], v244 offset:22528
  v_add_f32 v253, v253, v123
  v_cvt_pk_bf16_f32 v117, v122, v123
  v_fma_f32 v124, v124, s32, v249
  v_fma_f32 v125, v125, s32, v249
  v_exp_f32 v124, v124
  v_exp_f32 v125, v125
  v_add_f32 v248, v248, v124
  v_add_f32 v253, v253, v125
  v_mfma_f32_32x32x16_bf16 v[160:175], v[216:219], v[100:103], v[160:175]
  ds_read_b64_tr_b16 v[216:217], v245 offset:20480
  ds_read_b64_tr_b16 v[218:219], v245 offset:22528
  v_cvt_pk_bf16_f32 v118, v124, v125
  v_fma_f32 v126, v126, s32, v249
  v_fma_f32 v127, v127, s32, v249
  v_exp_f32 v126, v126
  v_exp_f32 v127, v127
  v_add_f32 v248, v248, v126
  v_add_f32 v253, v253, v127
  v_cvt_pk_bf16_f32 v119, v126, v127
  v_mfma_f32_32x32x16_bf16 v[176:191], v[220:223], v[100:103], v[176:191]
  ds_read_b64_tr_b16 v[220:221], v246 offset:20480
  ds_read_b64_tr_b16 v[222:223], v246 offset:22528
  v_add_f32 v248, v248, v253
  v_mov_b32 v250, v248
  s_nop 1
  v_permlane32_swap_b32 v248, v250
  v_add_f32 v248, v248, v250
  s_waitcnt lgkmcnt(0)
  s_barrier
  v_mfma_f32_32x32x16_bf16 v[128:143], v[192:195], v[112:115], v[128:143]
  v_mfma_f32_32x32x16_bf16 v[144:159], v[196:199], v[112:115], v[144:159]
  v_mfma_f32_32x32x16_bf16 v[160:175], v[200:203], v[112:115], v[160:175]
  v_mfma_f32_32x32x16_bf16 v[176:191], v[204:207], v[112:115], v[176:191]
  v_mfma_f32_32x32x16_bf16 v[128:143], v[208:211], v[116:119], v[128:143]
  v_mfma_f32_32x32x16_bf16 v[144:159], v[212:215], v[116:119], v[144:159]
  v_mfma_f32_32x32x16_bf16 v[160:175], v[216:219], v[116:119], v[160:175]
  v_mfma_f32_32x32x16_bf16 v[176:191], v[220:223], v[116:119], v[176:191]
  s_mul_i32 s29, s24, 0x2200
  v_lshlrev_b32 v255, 4, v224
  v_add_u32 v255, s29, v255
  v_lshlrev_b32 v252, 2, v224
  v_add_u32 v252, s29, v252
  ds_write_b32 v252, v247 offset:8192
  ds_write_b32 v252, v248 offset:8448
  s_nop 3
  ds_write_b128 v255, v[160:163]
  ds_write_b128 v255, v[164:167] offset:1024
  ds_write_b128 v255, v[168:171] offset:2048
  ds_write_b128 v255, v[172:175] offset:3072
  ds_write_b128 v255, v[176:179] offset:4096
  ds_write_b128 v255, v[180:183] offset:5120
  ds_write_b128 v255, v[184:187] offset:6144
  ds_write_b128 v255, v[188:191] offset:7168
  s_waitcnt lgkmcnt(0)
  s_barrier
  v_add_u32 v255, 0x8800, v255
  v_add_u32 v252, 0x8800, v252
  ds_read_b32 v250, v252 offset:8192
  ds_read_b32 v251, v252 offset:8448
  ds_read_b128 v[0:3], v255
  ds_read_b128 v[4:7], v255 offset:1024
  ds_read_b128 v[8:11], v255 offset:2048
  ds_read_b128 v[12:15], v255 offset:3072
  ds_read_b128 v[16:19], v255 offset:4096
  ds_read_b128 v[20:23], v255 offset:5120
  ds_read_b128 v[24:27], v255 offset:6144
  ds_read_b128 v[28:31], v255 offset:7168
  s_waitcnt lgkmcnt(9)
  v_max_f32 v253, v247, v250
  v_sub_f32 v247, v247, v253
  v_sub_f32 v250, v250, v253
  v_mul_f32 v247, s32, v247
  v_mul_f32 v250, s32, v250
  v_exp_f32 v247, v247
  v_exp_f32 v250, v250
  v_mul_f32 v248, v248, v247
  s_waitcnt lgkmcnt(8)
  v_fma_f32 v248, v251, v250, v248
  v_rcp_f32 v248, v248
  s_nop 0
  v_mul_f32 v247, v247, v248
  v_mul_f32 v250, v250, v248
  s_waitcnt lgkmcnt(7)
  v_mul_f32 v0, v0, v250
  v_fma_f32 v0, v128, v247, v0
  v_mul_f32 v1, v1, v250
  v_fma_f32 v1, v129, v247, v1
  v_mul_f32 v2, v2, v250
  v_fma_f32 v2, v130, v247, v2
  v_mul_f32 v3, v3, v250
  v_fma_f32 v3, v131, v247, v3
  s_waitcnt lgkmcnt(6)
  v_mul_f32 v4, v4, v250
  v_fma_f32 v4, v132, v247, v4
  v_mul_f32 v5, v5, v250
  v_fma_f32 v5, v133, v247, v5
  v_mul_f32 v6, v6, v250
  v_fma_f32 v6, v134, v247, v6
  v_mul_f32 v7, v7, v250
  v_fma_f32 v7, v135, v247, v7
  s_waitcnt lgkmcnt(5)
  v_mul_f32 v8, v8, v250
  v_fma_f32 v8, v136, v247, v8
  v_mul_f32 v9, v9, v250
  v_fma_f32 v9, v137, v247, v9
  v_mul_f32 v10, v10, v250
  v_fma_f32 v10, v138, v247, v10
  v_mul_f32 v11, v11, v250
  v_fma_f32 v11, v139, v247, v11
  s_waitcnt lgkmcnt(4)
  v_mul_f32 v12, v12, v250
  v_fma_f32 v12, v140, v247, v12
  v_mul_f32 v13, v13, v250
  v_fma_f32 v13, v141, v247, v13
  v_mul_f32 v14, v14, v250
  v_fma_f32 v14, v142, v247, v14
  v_mul_f32 v15, v15, v250
  v_fma_f32 v15, v143, v247, v15
  s_waitcnt lgkmcnt(3)
  v_mul_f32 v16, v16, v250
  v_fma_f32 v16, v144, v247, v16
  v_mul_f32 v17, v17, v250
  v_fma_f32 v17, v145, v247, v17
  v_mul_f32 v18, v18, v250
  v_fma_f32 v18, v146, v247, v18
  v_mul_f32 v19, v19, v250
  v_fma_f32 v19, v147, v247, v19
  s_waitcnt lgkmcnt(2)
  v_mul_f32 v20, v20, v250
  v_fma_f32 v20, v148, v247, v20
  v_mul_f32 v21, v21, v250
  v_fma_f32 v21, v149, v247, v21
  v_mul_f32 v22, v22, v250
  v_fma_f32 v22, v150, v247, v22
  v_mul_f32 v23, v23, v250
  v_fma_f32 v23, v151, v247, v23
  s_waitcnt lgkmcnt(1)
  v_mul_f32 v24, v24, v250
  v_fma_f32 v24, v152, v247, v24
  v_mul_f32 v25, v25, v250
  v_fma_f32 v25, v153, v247, v25
  v_mul_f32 v26, v26, v250
  v_fma_f32 v26, v154, v247, v26
  v_mul_f32 v27, v27, v250
  v_fma_f32 v27, v155, v247, v27
  s_waitcnt lgkmcnt(0)
  v_mul_f32 v28, v28, v250
  v_fma_f32 v28, v156, v247, v28
  v_mul_f32 v29, v29, v250
  v_fma_f32 v29, v157, v247, v29
  v_mul_f32 v30, v30, v250
  v_fma_f32 v30, v158, v247, v30
  v_mul_f32 v31, v31, v250
  v_fma_f32 v31, v159, v247, v31
  v_cvt_pk_bf16_f32 v32, v0, v1
  v_cvt_pk_bf16_f32 v33, v2, v3
  v_cvt_pk_bf16_f32 v34, v4, v5
  v_cvt_pk_bf16_f32 v35, v6, v7
  v_cvt_pk_bf16_f32 v36, v8, v9
  v_cvt_pk_bf16_f32 v37, v10, v11
  v_cvt_pk_bf16_f32 v38, v12, v13
  v_cvt_pk_bf16_f32 v39, v14, v15
  v_cvt_pk_bf16_f32 v40, v16, v17
  v_cvt_pk_bf16_f32 v41, v18, v19
  v_cvt_pk_bf16_f32 v42, v20, v21
  v_cvt_pk_bf16_f32 v43, v22, v23
  v_cvt_pk_bf16_f32 v44, v24, v25
  v_cvt_pk_bf16_f32 v45, v26, v27
  v_cvt_pk_bf16_f32 v46, v28, v29
  v_cvt_pk_bf16_f32 v47, v30, v31
  s_lshl_b32 s29, s2, 2
  s_add_u32 s29, s29, s26
  s_lshl_b32 s29, s29, 13
  s_add_u32 s29, s29, 0
  v_lshlrev_b32 v254, 4, v224
  v_add_u32 v254, s29, v254
  buffer_store_dwordx4 v[32:35], v254, s[20:23], 0 offen
  buffer_store_dwordx4 v[36:39], v254, s[20:23], 0 offen offset:1024
  buffer_store_dwordx4 v[40:43], v254, s[20:23], 0 offen offset:2048
  buffer_store_dwordx4 v[44:47], v254, s[20:23], 0 offen offset:3072
  s_endpgm
.LROLE1:
  v_lshrrev_b32 v250, 4, v224
  v_add_u32 v251, 0, v250
  v_xor_b32 v251, v251, v224
  v_and_b32 v251, 15, v251
  v_lshlrev_b32 v251, 4, v251
  v_lshl_add_u32 v230, v250, 8, v251
  v_add_u32 v251, 4, v250
  v_xor_b32 v251, v251, v224
  v_and_b32 v251, 15, v251
  v_lshlrev_b32 v251, 4, v251
  v_lshl_add_u32 v231, v250, 8, v251
  v_add_u32 v251, 8, v250
  v_xor_b32 v251, v251, v224
  v_and_b32 v251, 15, v251
  v_lshlrev_b32 v251, 4, v251
  v_lshl_add_u32 v232, v250, 8, v251
  v_add_u32 v251, 12, v250
  v_xor_b32 v251, v251, v224
  v_and_b32 v251, 15, v251
  v_lshlrev_b32 v251, 4, v251
  v_lshl_add_u32 v233, v250, 8, v251
  v_lshlrev_b32 v251, 2, v250
  v_xor_b32 v251, v251, v224
  v_and_b32 v251, 15, v251
  v_lshlrev_b32 v251, 4, v251
  v_lshl_add_u32 v234, v250, 8, v251
  s_lshl_b32 s33, s27, 2
  s_add_u32 s33, s33, s35
  s_mul_i32 s29, s33, 0x118
  s_mul_i32 s30, s26, 0x46
  s_add_u32 s29, s29, s30
  v_add_u32 v250, s29, v224
  v_lshlrev_b32 v250, 7, v250
  buffer_load_dword v252, v250, s[4:7], 0 offen
  v_add_u32 v250, 0x300, v250
  buffer_load_dword v252, v250, s[4:7], 0 offen
  s_lshr_b32 s29, s33, 2
  s_mul_i32 s29, s29, 0x50
  s_mul_i32 s30, s26, 20
  s_add_u32 s29, s29, s30
  v_lshrrev_b32 v250, 1, v224
  v_min_u32 v250, 19, v250
  v_add_u32 v250, s29, v250
  v_lshlrev_b32 v250, 13, v250
  v_and_b32 v251, 1, v224
  v_lshl_add_u32 v250, v251, 7, v250
  s_and_b32 s29, s33, 3
  s_lshl_b32 s29, s29, 3
  s_add_u32 s29, s29, s34
  s_lshl_b32 s29, s29, 8
  buffer_load_dword v252, v250, s[8:11], s29 offen
  v_lshlrev_b32 v254, 7, v224
  v_and_b32 v250, 31, v224
  v_lshrrev_b32 v251, 5, v224
  s_lshl_b32 s29, s26, 5
  v_add_u32 v253, s29, v250
  v_lshrrev_b32 v255, 2, v253
  v_and_b32 v255, 3, v255
  v_xor_b32 v255, v255, v251
  v_lshlrev_b32 v253, 6, v253
  v_lshl_add_u32 v225, v255, 4, v253
  v_add_u32 v225, 0, v225
  v_xor_b32 v226, 32, v225
  v_lshrrev_b32 v247, 2, v224
  v_and_b32 v247, 3, v247
  v_and_b32 v248, 1, v224
  v_lshlrev_b32 v248, 4, v248
  v_and_b32 v253, 2, v224
  v_lshl_add_u32 v248, v253, 2, v248
  v_and_b32 v253, 16, v224
  v_lshl_add_u32 v248, v253, 1, v248
  v_lshl_add_u32 v253, v251, 3, v247
  v_lshl_add_u32 v253, v253, 8, v248
  v_add_u32 v253, 0x2000, v253
  v_xor_b32 v255, 1, v247
  v_lshl_add_u32 v227, v255, 6, v253
  v_xor_b32 v255, 2, v247
  v_lshl_add_u32 v228, v255, 6, v253
  v_xor_b32 v255, 3, v247
  v_lshl_add_u32 v229, v255, 6, v253
  v_lshl_add_u32 v253, v251, 2, v247
  v_add_u32 v253, 32, v253
  v_lshl_add_u32 v253, v253, 8, v248
  v_xor_b32 v255, 0, v247
  v_lshl_add_u32 v243, v255, 6, v253
  v_xor_b32 v255, 1, v247
  v_lshl_add_u32 v244, v255, 6, v253
  v_xor_b32 v255, 2, v247
  v_lshl_add_u32 v245, v255, 6, v253
  v_xor_b32 v255, 3, v247
  v_lshl_add_u32 v246, v255, 6, v253
  v_add_u32 v253, 32, v250
  v_and_b32 v255, 15, v253
  v_xor_b32 v255, v255, v251
  v_lshlrev_b32 v253, 8, v253
  v_lshl_add_u32 v235, v255, 4, v253
  v_xor_b32 v236, 32, v235
  v_xor_b32 v237, 64, v235
  v_xor_b32 v238, 0x60, v235
  v_xor_b32 v239, 0x80, v235
  v_xor_b32 v240, 0xa0, v235
  v_xor_b32 v241, 0xc0, v235
  v_xor_b32 v242, 0xe0, v235
  s_barrier
  ds_read_b128 v[0:3], v225
  ds_read_b64_tr_b16 v[8:9], v227
  ds_read_b64_tr_b16 v[10:11], v227 offset:1024
  ds_read_b64_tr_b16 v[12:13], v228
  ds_read_b64_tr_b16 v[14:15], v228 offset:1024
  ds_read_b64_tr_b16 v[16:17], v229
  ds_read_b64_tr_b16 v[18:19], v229 offset:1024
  ds_read_b128 v[4:7], v226
  ds_read_b64_tr_b16 v[20:21], v227 offset:4096
  ds_read_b64_tr_b16 v[22:23], v227 offset:5120
  ds_read_b64_tr_b16 v[24:25], v228 offset:4096
  ds_read_b64_tr_b16 v[26:27], v228 offset:5120
  ds_read_b64_tr_b16 v[28:29], v229 offset:4096
  ds_read_b64_tr_b16 v[30:31], v229 offset:5120
  s_waitcnt lgkmcnt(0)
  s_barrier
  ds_read_b128 v[32:35], v225 offset:16384
  ds_read_b64_tr_b16 v[40:41], v227 offset:16384
  ds_read_b64_tr_b16 v[42:43], v227 offset:17408
  ds_read_b64_tr_b16 v[44:45], v228 offset:16384
  ds_read_b64_tr_b16 v[46:47], v228 offset:17408
  ds_read_b64_tr_b16 v[48:49], v229 offset:16384
  ds_read_b64_tr_b16 v[50:51], v229 offset:17408
  ds_read_b128 v[36:39], v226 offset:16384
  ds_read_b64_tr_b16 v[52:53], v227 offset:20480
  ds_read_b64_tr_b16 v[54:55], v227 offset:21504
  ds_read_b64_tr_b16 v[56:57], v228 offset:20480
  ds_read_b64_tr_b16 v[58:59], v228 offset:21504
  ds_read_b64_tr_b16 v[60:61], v229 offset:20480
  ds_read_b64_tr_b16 v[62:63], v229 offset:21504
  v_mfma_f32_32x32x16_bf16 v[128:143], v[8:11], v[0:3], 0
  v_mfma_f32_32x32x16_bf16 v[144:159], v[12:15], v[0:3], 0
  v_mfma_f32_32x32x16_bf16 v[160:175], v[16:19], v[0:3], 0
  v_mfma_f32_32x32x16_bf16 v[128:143], v[20:23], v[4:7], v[128:143]
  v_mfma_f32_32x32x16_bf16 v[144:159], v[24:27], v[4:7], v[144:159]
  v_mfma_f32_32x32x16_bf16 v[160:175], v[28:31], v[4:7], v[160:175]
  s_waitcnt lgkmcnt(0)
  s_barrier
  ds_read_b128 v[0:3], v225 offset:32768
  ds_read_b64_tr_b16 v[8:9], v227 offset:32768
  ds_read_b64_tr_b16 v[10:11], v227 offset:33792
  ds_read_b64_tr_b16 v[12:13], v228 offset:32768
  ds_read_b64_tr_b16 v[14:15], v228 offset:33792
  ds_read_b64_tr_b16 v[16:17], v229 offset:32768
  ds_read_b64_tr_b16 v[18:19], v229 offset:33792
  ds_read_b128 v[4:7], v226 offset:32768
  ds_read_b64_tr_b16 v[20:21], v227 offset:36864
  ds_read_b64_tr_b16 v[22:23], v227 offset:37888
  ds_read_b64_tr_b16 v[24:25], v228 offset:36864
  ds_read_b64_tr_b16 v[26:27], v228 offset:37888
  ds_read_b64_tr_b16 v[28:29], v229 offset:36864
  ds_read_b64_tr_b16 v[30:31], v229 offset:37888
  v_mfma_f32_32x32x16_bf16 v[128:143], v[40:43], v[32:35], v[128:143]
  v_mfma_f32_32x32x16_bf16 v[144:159], v[44:47], v[32:35], v[144:159]
  v_mfma_f32_32x32x16_bf16 v[160:175], v[48:51], v[32:35], v[160:175]
  v_mfma_f32_32x32x16_bf16 v[128:143], v[52:55], v[36:39], v[128:143]
  v_mfma_f32_32x32x16_bf16 v[144:159], v[56:59], v[36:39], v[144:159]
  v_mfma_f32_32x32x16_bf16 v[160:175], v[60:63], v[36:39], v[160:175]
  s_waitcnt lgkmcnt(0)
  s_barrier
  ds_read_b128 v[32:35], v225 offset:49152
  ds_read_b64_tr_b16 v[40:41], v227 offset:49152
  ds_read_b64_tr_b16 v[42:43], v227 offset:50176
  ds_read_b64_tr_b16 v[44:45], v228 offset:49152
  ds_read_b64_tr_b16 v[46:47], v228 offset:50176
  ds_read_b64_tr_b16 v[48:49], v229 offset:49152
  ds_read_b64_tr_b16 v[50:51], v229 offset:50176
  ds_read_b128 v[36:39], v226 offset:49152
  ds_read_b64_tr_b16 v[52:53], v227 offset:53248
  ds_read_b64_tr_b16 v[54:55], v227 offset:54272
  ds_read_b64_tr_b16 v[56:57], v228 offset:53248
  ds_read_b64_tr_b16 v[58:59], v228 offset:54272
  ds_read_b64_tr_b16 v[60:61], v229 offset:53248
  ds_read_b64_tr_b16 v[62:63], v229 offset:54272
  v_mfma_f32_32x32x16_bf16 v[128:143], v[8:11], v[0:3], v[128:143]
  v_mfma_f32_32x32x16_bf16 v[144:159], v[12:15], v[0:3], v[144:159]
  v_mfma_f32_32x32x16_bf16 v[160:175], v[16:19], v[0:3], v[160:175]
  v_mfma_f32_32x32x16_bf16 v[128:143], v[20:23], v[4:7], v[128:143]
  v_mfma_f32_32x32x16_bf16 v[144:159], v[24:27], v[4:7], v[144:159]
  v_mfma_f32_32x32x16_bf16 v[160:175], v[28:31], v[4:7], v[160:175]
  s_waitcnt lgkmcnt(0)
  s_barrier
  v_add_u32 v225, 0x10000, v225
  v_add_u32 v226, 0x10000, v226
  v_add_u32 v227, 0x10000, v227
  v_add_u32 v228, 0x10000, v228
  v_add_u32 v229, 0x10000, v229
  ds_read_b128 v[0:3], v225
  ds_read_b64_tr_b16 v[8:9], v227
  ds_read_b64_tr_b16 v[10:11], v227 offset:1024
  ds_read_b64_tr_b16 v[12:13], v228
  ds_read_b64_tr_b16 v[14:15], v228 offset:1024
  ds_read_b64_tr_b16 v[16:17], v229
  ds_read_b64_tr_b16 v[18:19], v229 offset:1024
  ds_read_b128 v[4:7], v226
  ds_read_b64_tr_b16 v[20:21], v227 offset:4096
  ds_read_b64_tr_b16 v[22:23], v227 offset:5120
  ds_read_b64_tr_b16 v[24:25], v228 offset:4096
  ds_read_b64_tr_b16 v[26:27], v228 offset:5120
  ds_read_b64_tr_b16 v[28:29], v229 offset:4096
  ds_read_b64_tr_b16 v[30:31], v229 offset:5120
  v_mfma_f32_32x32x16_bf16 v[128:143], v[40:43], v[32:35], v[128:143]
  v_mfma_f32_32x32x16_bf16 v[144:159], v[44:47], v[32:35], v[144:159]
  v_mfma_f32_32x32x16_bf16 v[160:175], v[48:51], v[32:35], v[160:175]
  v_mfma_f32_32x32x16_bf16 v[128:143], v[52:55], v[36:39], v[128:143]
  v_mfma_f32_32x32x16_bf16 v[144:159], v[56:59], v[36:39], v[144:159]
  v_mfma_f32_32x32x16_bf16 v[160:175], v[60:63], v[36:39], v[160:175]
  s_waitcnt lgkmcnt(0)
  s_barrier
  ds_read_b128 v[32:35], v225 offset:16384
  ds_read_b64_tr_b16 v[40:41], v227 offset:16384
  ds_read_b64_tr_b16 v[42:43], v227 offset:17408
  ds_read_b64_tr_b16 v[44:45], v228 offset:16384
  ds_read_b64_tr_b16 v[46:47], v228 offset:17408
  ds_read_b64_tr_b16 v[48:49], v229 offset:16384
  ds_read_b64_tr_b16 v[50:51], v229 offset:17408
  ds_read_b128 v[36:39], v226 offset:16384
  ds_read_b64_tr_b16 v[52:53], v227 offset:20480
  ds_read_b64_tr_b16 v[54:55], v227 offset:21504
  ds_read_b64_tr_b16 v[56:57], v228 offset:20480
  ds_read_b64_tr_b16 v[58:59], v228 offset:21504
  ds_read_b64_tr_b16 v[60:61], v229 offset:20480
  ds_read_b64_tr_b16 v[62:63], v229 offset:21504
  v_mfma_f32_32x32x16_bf16 v[128:143], v[8:11], v[0:3], v[128:143]
  v_mfma_f32_32x32x16_bf16 v[144:159], v[12:15], v[0:3], v[144:159]
  v_mfma_f32_32x32x16_bf16 v[160:175], v[16:19], v[0:3], v[160:175]
  v_mfma_f32_32x32x16_bf16 v[128:143], v[20:23], v[4:7], v[128:143]
  v_mfma_f32_32x32x16_bf16 v[144:159], v[24:27], v[4:7], v[144:159]
  v_mfma_f32_32x32x16_bf16 v[160:175], v[28:31], v[4:7], v[160:175]
  s_waitcnt lgkmcnt(0)
  s_barrier
  ds_read_b128 v[0:3], v225 offset:32768
  ds_read_b64_tr_b16 v[8:9], v227 offset:32768
  ds_read_b64_tr_b16 v[10:11], v227 offset:33792
  ds_read_b64_tr_b16 v[12:13], v228 offset:32768
  ds_read_b64_tr_b16 v[14:15], v228 offset:33792
  ds_read_b64_tr_b16 v[16:17], v229 offset:32768
  ds_read_b64_tr_b16 v[18:19], v229 offset:33792
  ds_read_b128 v[4:7], v226 offset:32768
  ds_read_b64_tr_b16 v[20:21], v227 offset:36864
  ds_read_b64_tr_b16 v[22:23], v227 offset:37888
  ds_read_b64_tr_b16 v[24:25], v228 offset:36864
  ds_read_b64_tr_b16 v[26:27], v228 offset:37888
  ds_read_b64_tr_b16 v[28:29], v229 offset:36864
  ds_read_b64_tr_b16 v[30:31], v229 offset:37888
  v_mfma_f32_32x32x16_bf16 v[128:143], v[40:43], v[32:35], v[128:143]
  v_mfma_f32_32x32x16_bf16 v[144:159], v[44:47], v[32:35], v[144:159]
  v_mfma_f32_32x32x16_bf16 v[160:175], v[48:51], v[32:35], v[160:175]
  v_mfma_f32_32x32x16_bf16 v[128:143], v[52:55], v[36:39], v[128:143]
  v_mfma_f32_32x32x16_bf16 v[144:159], v[56:59], v[36:39], v[144:159]
  v_mfma_f32_32x32x16_bf16 v[160:175], v[60:63], v[36:39], v[160:175]
  s_waitcnt lgkmcnt(0)
  s_barrier
  ds_read_b128 v[32:35], v225 offset:49152
  ds_read_b64_tr_b16 v[40:41], v227 offset:49152
  ds_read_b64_tr_b16 v[42:43], v227 offset:50176
  ds_read_b64_tr_b16 v[44:45], v228 offset:49152
  ds_read_b64_tr_b16 v[46:47], v228 offset:50176
  ds_read_b64_tr_b16 v[48:49], v229 offset:49152
  ds_read_b64_tr_b16 v[50:51], v229 offset:50176
  ds_read_b128 v[36:39], v226 offset:49152
  ds_read_b64_tr_b16 v[52:53], v227 offset:53248
  ds_read_b64_tr_b16 v[54:55], v227 offset:54272
  ds_read_b64_tr_b16 v[56:57], v228 offset:53248
  ds_read_b64_tr_b16 v[58:59], v228 offset:54272
  ds_read_b64_tr_b16 v[60:61], v229 offset:53248
  ds_read_b64_tr_b16 v[62:63], v229 offset:54272
  v_mfma_f32_32x32x16_bf16 v[128:143], v[8:11], v[0:3], v[128:143]
  v_mfma_f32_32x32x16_bf16 v[144:159], v[12:15], v[0:3], v[144:159]
  v_mfma_f32_32x32x16_bf16 v[160:175], v[16:19], v[0:3], v[160:175]
  v_mfma_f32_32x32x16_bf16 v[128:143], v[20:23], v[4:7], v[128:143]
  v_mfma_f32_32x32x16_bf16 v[144:159], v[24:27], v[4:7], v[144:159]
  v_mfma_f32_32x32x16_bf16 v[160:175], v[28:31], v[4:7], v[160:175]
  s_waitcnt lgkmcnt(0)
  s_barrier
  v_add_u32 v225, 0x10000, v225
  v_add_u32 v226, 0x10000, v226
  v_add_u32 v227, 0x10000, v227
  v_add_u32 v228, 0x10000, v228
  v_add_u32 v229, 0x10000, v229
  ds_read_b128 v[0:3], v225
  ds_read_b64_tr_b16 v[8:9], v227
  ds_read_b64_tr_b16 v[10:11], v227 offset:1024
  ds_read_b64_tr_b16 v[12:13], v228
  ds_read_b64_tr_b16 v[14:15], v228 offset:1024
  ds_read_b64_tr_b16 v[16:17], v229
  ds_read_b64_tr_b16 v[18:19], v229 offset:1024
  ds_read_b128 v[4:7], v226
  ds_read_b64_tr_b16 v[20:21], v227 offset:4096
  ds_read_b64_tr_b16 v[22:23], v227 offset:5120
  ds_read_b64_tr_b16 v[24:25], v228 offset:4096
  ds_read_b64_tr_b16 v[26:27], v228 offset:5120
  ds_read_b64_tr_b16 v[28:29], v229 offset:4096
  ds_read_b64_tr_b16 v[30:31], v229 offset:5120
  v_mfma_f32_32x32x16_bf16 v[128:143], v[40:43], v[32:35], v[128:143]
  v_mfma_f32_32x32x16_bf16 v[144:159], v[44:47], v[32:35], v[144:159]
  v_mfma_f32_32x32x16_bf16 v[160:175], v[48:51], v[32:35], v[160:175]
  v_mfma_f32_32x32x16_bf16 v[128:143], v[52:55], v[36:39], v[128:143]
  v_mfma_f32_32x32x16_bf16 v[144:159], v[56:59], v[36:39], v[144:159]
  v_mfma_f32_32x32x16_bf16 v[160:175], v[60:63], v[36:39], v[160:175]
  s_waitcnt lgkmcnt(0)
  s_barrier
  ds_read_b128 v[32:35], v225 offset:16384
  ds_read_b64_tr_b16 v[40:41], v227 offset:16384
  ds_read_b64_tr_b16 v[42:43], v227 offset:17408
  ds_read_b64_tr_b16 v[44:45], v228 offset:16384
  ds_read_b64_tr_b16 v[46:47], v228 offset:17408
  ds_read_b64_tr_b16 v[48:49], v229 offset:16384
  ds_read_b64_tr_b16 v[50:51], v229 offset:17408
  ds_read_b128 v[36:39], v226 offset:16384
  ds_read_b64_tr_b16 v[52:53], v227 offset:20480
  ds_read_b64_tr_b16 v[54:55], v227 offset:21504
  ds_read_b64_tr_b16 v[56:57], v228 offset:20480
  ds_read_b64_tr_b16 v[58:59], v228 offset:21504
  ds_read_b64_tr_b16 v[60:61], v229 offset:20480
  ds_read_b64_tr_b16 v[62:63], v229 offset:21504
  v_mfma_f32_32x32x16_bf16 v[128:143], v[8:11], v[0:3], v[128:143]
  v_mfma_f32_32x32x16_bf16 v[144:159], v[12:15], v[0:3], v[144:159]
  v_mfma_f32_32x32x16_bf16 v[160:175], v[16:19], v[0:3], v[160:175]
  v_mfma_f32_32x32x16_bf16 v[128:143], v[20:23], v[4:7], v[128:143]
  v_mfma_f32_32x32x16_bf16 v[144:159], v[24:27], v[4:7], v[144:159]
  v_mfma_f32_32x32x16_bf16 v[160:175], v[28:31], v[4:7], v[160:175]
  s_waitcnt lgkmcnt(0)
  s_barrier
  v_add_u32 v225, 0xfffe0000, v225
  v_add_u32 v226, 0xfffe0000, v226
  v_add_u32 v227, 0xfffe0000, v227
  v_add_u32 v228, 0xfffe0000, v228
  v_add_u32 v229, 0xfffe0000, v229
  ds_read_b128 v[0:3], v225
  ds_read_b64_tr_b16 v[8:9], v227
  ds_read_b64_tr_b16 v[10:11], v227 offset:1024
  ds_read_b64_tr_b16 v[12:13], v228
  ds_read_b64_tr_b16 v[14:15], v228 offset:1024
  ds_read_b64_tr_b16 v[16:17], v229
  ds_read_b64_tr_b16 v[18:19], v229 offset:1024
  ds_read_b128 v[4:7], v226
  ds_read_b64_tr_b16 v[20:21], v227 offset:4096
  ds_read_b64_tr_b16 v[22:23], v227 offset:5120
  ds_read_b64_tr_b16 v[24:25], v228 offset:4096
  ds_read_b64_tr_b16 v[26:27], v228 offset:5120
  ds_read_b64_tr_b16 v[28:29], v229 offset:4096
  ds_read_b64_tr_b16 v[30:31], v229 offset:5120
  v_mfma_f32_32x32x16_bf16 v[128:143], v[40:43], v[32:35], v[128:143]
  v_mfma_f32_32x32x16_bf16 v[144:159], v[44:47], v[32:35], v[144:159]
  v_mfma_f32_32x32x16_bf16 v[160:175], v[48:51], v[32:35], v[160:175]
  v_mfma_f32_32x32x16_bf16 v[128:143], v[52:55], v[36:39], v[128:143]
  v_mfma_f32_32x32x16_bf16 v[144:159], v[56:59], v[36:39], v[144:159]
  v_mfma_f32_32x32x16_bf16 v[160:175], v[60:63], v[36:39], v[160:175]
  s_waitcnt lgkmcnt(0)
  s_barrier
  ds_read_b128 v[32:35], v225 offset:16384
  ds_read_b64_tr_b16 v[40:41], v227 offset:16384
  ds_read_b64_tr_b16 v[42:43], v227 offset:17408
  ds_read_b64_tr_b16 v[44:45], v228 offset:16384
  ds_read_b64_tr_b16 v[46:47], v228 offset:17408
  ds_read_b64_tr_b16 v[48:49], v229 offset:16384
  ds_read_b64_tr_b16 v[50:51], v229 offset:17408
  ds_read_b128 v[36:39], v226 offset:16384
  ds_read_b64_tr_b16 v[52:53], v227 offset:20480
  ds_read_b64_tr_b16 v[54:55], v227 offset:21504
  ds_read_b64_tr_b16 v[56:57], v228 offset:20480
  ds_read_b64_tr_b16 v[58:59], v228 offset:21504
  ds_read_b64_tr_b16 v[60:61], v229 offset:20480
  ds_read_b64_tr_b16 v[62:63], v229 offset:21504
  v_mfma_f32_32x32x16_bf16 v[128:143], v[8:11], v[0:3], v[128:143]
  v_mfma_f32_32x32x16_bf16 v[144:159], v[12:15], v[0:3], v[144:159]
  v_mfma_f32_32x32x16_bf16 v[160:175], v[16:19], v[0:3], v[160:175]
  v_mfma_f32_32x32x16_bf16 v[128:143], v[20:23], v[4:7], v[128:143]
  v_mfma_f32_32x32x16_bf16 v[144:159], v[24:27], v[4:7], v[144:159]
  v_mfma_f32_32x32x16_bf16 v[160:175], v[28:31], v[4:7], v[160:175]
  s_add_u32 m0, s31, 0
  s_add_u32 s30, s31, 0
  buffer_load_dwordx4 v230, s[12:15], s30 offen nt lds
  buffer_load_dwordx4 v231, s[12:15], s30 offen offset:1024 nt lds
  buffer_load_dwordx4 v232, s[12:15], s30 offen offset:2048 nt lds
  buffer_load_dwordx4 v233, s[12:15], s30 offen offset:3072 nt lds
  s_waitcnt lgkmcnt(0)
  s_barrier
  ds_read_b128 v[0:3], v225 offset:32768
  ds_read_b64_tr_b16 v[8:9], v227 offset:32768
  ds_read_b64_tr_b16 v[10:11], v227 offset:33792
  ds_read_b64_tr_b16 v[12:13], v228 offset:32768
  ds_read_b64_tr_b16 v[14:15], v228 offset:33792
  ds_read_b64_tr_b16 v[16:17], v229 offset:32768
  ds_read_b64_tr_b16 v[18:19], v229 offset:33792
  ds_read_b128 v[4:7], v226 offset:32768
  ds_read_b64_tr_b16 v[20:21], v227 offset:36864
  ds_read_b64_tr_b16 v[22:23], v227 offset:37888
  ds_read_b64_tr_b16 v[24:25], v228 offset:36864
  ds_read_b64_tr_b16 v[26:27], v228 offset:37888
  ds_read_b64_tr_b16 v[28:29], v229 offset:36864
  ds_read_b64_tr_b16 v[30:31], v229 offset:37888
  v_mfma_f32_32x32x16_bf16 v[128:143], v[40:43], v[32:35], v[128:143]
  v_mfma_f32_32x32x16_bf16 v[144:159], v[44:47], v[32:35], v[144:159]
  v_mfma_f32_32x32x16_bf16 v[160:175], v[48:51], v[32:35], v[160:175]
  v_mfma_f32_32x32x16_bf16 v[128:143], v[52:55], v[36:39], v[128:143]
  v_mfma_f32_32x32x16_bf16 v[144:159], v[56:59], v[36:39], v[144:159]
  v_mfma_f32_32x32x16_bf16 v[160:175], v[60:63], v[36:39], v[160:175]
  s_add_u32 m0, s31, 0x4000
  s_add_u32 s30, s31, 0x4000
  buffer_load_dwordx4 v230, s[12:15], s30 offen nt lds
  buffer_load_dwordx4 v231, s[12:15], s30 offen offset:1024 nt lds
  buffer_load_dwordx4 v232, s[12:15], s30 offen offset:2048 nt lds
  buffer_load_dwordx4 v233, s[12:15], s30 offen offset:3072 nt lds
  s_waitcnt lgkmcnt(0)
  s_barrier
  ds_read_b128 v[32:35], v225 offset:49152
  ds_read_b64_tr_b16 v[40:41], v227 offset:49152
  ds_read_b64_tr_b16 v[42:43], v227 offset:50176
  ds_read_b64_tr_b16 v[44:45], v228 offset:49152
  ds_read_b64_tr_b16 v[46:47], v228 offset:50176
  ds_read_b64_tr_b16 v[48:49], v229 offset:49152
  ds_read_b64_tr_b16 v[50:51], v229 offset:50176
  ds_read_b128 v[36:39], v226 offset:49152
  ds_read_b64_tr_b16 v[52:53], v227 offset:53248
  ds_read_b64_tr_b16 v[54:55], v227 offset:54272
  ds_read_b64_tr_b16 v[56:57], v228 offset:53248
  ds_read_b64_tr_b16 v[58:59], v228 offset:54272
  ds_read_b64_tr_b16 v[60:61], v229 offset:53248
  ds_read_b64_tr_b16 v[62:63], v229 offset:54272
  v_mfma_f32_32x32x16_bf16 v[128:143], v[8:11], v[0:3], v[128:143]
  v_mfma_f32_32x32x16_bf16 v[144:159], v[12:15], v[0:3], v[144:159]
  v_mfma_f32_32x32x16_bf16 v[160:175], v[16:19], v[0:3], v[160:175]
  v_mfma_f32_32x32x16_bf16 v[128:143], v[20:23], v[4:7], v[128:143]
  v_mfma_f32_32x32x16_bf16 v[144:159], v[24:27], v[4:7], v[144:159]
  v_mfma_f32_32x32x16_bf16 v[160:175], v[28:31], v[4:7], v[160:175]
  s_add_u32 m0, s31, 0x8000
  s_add_u32 s30, s31, 0x8000
  buffer_load_dwordx4 v230, s[12:15], s30 offen nt lds
  buffer_load_dwordx4 v231, s[12:15], s30 offen offset:1024 nt lds
  buffer_load_dwordx4 v232, s[12:15], s30 offen offset:2048 nt lds
  buffer_load_dwordx4 v233, s[12:15], s30 offen offset:3072 nt lds
  s_waitcnt lgkmcnt(0)
  s_barrier
  v_add_u32 v225, 0x10000, v225
  v_add_u32 v226, 0x10000, v226
  v_add_u32 v227, 0x10000, v227
  v_add_u32 v228, 0x10000, v228
  v_add_u32 v229, 0x10000, v229
  ds_read_b128 v[0:3], v225
  ds_read_b64_tr_b16 v[8:9], v227
  ds_read_b64_tr_b16 v[10:11], v227 offset:1024
  ds_read_b64_tr_b16 v[12:13], v228
  ds_read_b64_tr_b16 v[14:15], v228 offset:1024
  ds_read_b64_tr_b16 v[16:17], v229
  ds_read_b64_tr_b16 v[18:19], v229 offset:1024
  ds_read_b128 v[4:7], v226
  ds_read_b64_tr_b16 v[20:21], v227 offset:4096
  ds_read_b64_tr_b16 v[22:23], v227 offset:5120
  ds_read_b64_tr_b16 v[24:25], v228 offset:4096
  ds_read_b64_tr_b16 v[26:27], v228 offset:5120
  ds_read_b64_tr_b16 v[28:29], v229 offset:4096
  ds_read_b64_tr_b16 v[30:31], v229 offset:5120
  v_mfma_f32_32x32x16_bf16 v[128:143], v[40:43], v[32:35], v[128:143]
  v_mfma_f32_32x32x16_bf16 v[144:159], v[44:47], v[32:35], v[144:159]
  v_mfma_f32_32x32x16_bf16 v[160:175], v[48:51], v[32:35], v[160:175]
  v_mfma_f32_32x32x16_bf16 v[128:143], v[52:55], v[36:39], v[128:143]
  v_mfma_f32_32x32x16_bf16 v[144:159], v[56:59], v[36:39], v[144:159]
  v_mfma_f32_32x32x16_bf16 v[160:175], v[60:63], v[36:39], v[160:175]
  s_waitcnt lgkmcnt(0)
  s_barrier
  ds_read_b128 v[32:35], v225 offset:16384
  ds_read_b64_tr_b16 v[40:41], v227 offset:16384
  ds_read_b64_tr_b16 v[42:43], v227 offset:17408
  ds_read_b64_tr_b16 v[44:45], v228 offset:16384
  ds_read_b64_tr_b16 v[46:47], v228 offset:17408
  ds_read_b64_tr_b16 v[48:49], v229 offset:16384
  ds_read_b64_tr_b16 v[50:51], v229 offset:17408
  ds_read_b128 v[36:39], v226 offset:16384
  ds_read_b64_tr_b16 v[52:53], v227 offset:20480
  ds_read_b64_tr_b16 v[54:55], v227 offset:21504
  ds_read_b64_tr_b16 v[56:57], v228 offset:20480
  ds_read_b64_tr_b16 v[58:59], v228 offset:21504
  ds_read_b64_tr_b16 v[60:61], v229 offset:20480
  ds_read_b64_tr_b16 v[62:63], v229 offset:21504
  v_mfma_f32_32x32x16_bf16 v[128:143], v[8:11], v[0:3], v[128:143]
  v_mfma_f32_32x32x16_bf16 v[144:159], v[12:15], v[0:3], v[144:159]
  v_mfma_f32_32x32x16_bf16 v[160:175], v[16:19], v[0:3], v[160:175]
  v_mfma_f32_32x32x16_bf16 v[128:143], v[20:23], v[4:7], v[128:143]
  v_mfma_f32_32x32x16_bf16 v[144:159], v[24:27], v[4:7], v[144:159]
  v_mfma_f32_32x32x16_bf16 v[160:175], v[28:31], v[4:7], v[160:175]
  s_waitcnt lgkmcnt(0)
  s_barrier
  ds_read_b128 v[0:3], v225 offset:32768
  ds_read_b64_tr_b16 v[8:9], v227 offset:32768
  ds_read_b64_tr_b16 v[10:11], v227 offset:33792
  ds_read_b64_tr_b16 v[12:13], v228 offset:32768
  ds_read_b64_tr_b16 v[14:15], v228 offset:33792
  ds_read_b64_tr_b16 v[16:17], v229 offset:32768
  ds_read_b64_tr_b16 v[18:19], v229 offset:33792
  ds_read_b128 v[4:7], v226 offset:32768
  ds_read_b64_tr_b16 v[20:21], v227 offset:36864
  ds_read_b64_tr_b16 v[22:23], v227 offset:37888
  ds_read_b64_tr_b16 v[24:25], v228 offset:36864
  ds_read_b64_tr_b16 v[26:27], v228 offset:37888
  ds_read_b64_tr_b16 v[28:29], v229 offset:36864
  ds_read_b64_tr_b16 v[30:31], v229 offset:37888
  v_mfma_f32_32x32x16_bf16 v[128:143], v[40:43], v[32:35], v[128:143]
  v_mfma_f32_32x32x16_bf16 v[144:159], v[44:47], v[32:35], v[144:159]
  v_mfma_f32_32x32x16_bf16 v[160:175], v[48:51], v[32:35], v[160:175]
  v_mfma_f32_32x32x16_bf16 v[128:143], v[52:55], v[36:39], v[128:143]
  v_mfma_f32_32x32x16_bf16 v[144:159], v[56:59], v[36:39], v[144:159]
  v_mfma_f32_32x32x16_bf16 v[160:175], v[60:63], v[36:39], v[160:175]
  s_waitcnt lgkmcnt(0)
  s_barrier
  ds_read_b128 v[32:35], v225 offset:49152
  ds_read_b64_tr_b16 v[40:41], v227 offset:49152
  ds_read_b64_tr_b16 v[42:43], v227 offset:50176
  ds_read_b64_tr_b16 v[44:45], v228 offset:49152
  ds_read_b64_tr_b16 v[46:47], v228 offset:50176
  ds_read_b64_tr_b16 v[48:49], v229 offset:49152
  ds_read_b64_tr_b16 v[50:51], v229 offset:50176
  ds_read_b128 v[36:39], v226 offset:49152
  ds_read_b64_tr_b16 v[52:53], v227 offset:53248
  ds_read_b64_tr_b16 v[54:55], v227 offset:54272
  ds_read_b64_tr_b16 v[56:57], v228 offset:53248
  ds_read_b64_tr_b16 v[58:59], v228 offset:54272
  ds_read_b64_tr_b16 v[60:61], v229 offset:53248
  ds_read_b64_tr_b16 v[62:63], v229 offset:54272
  v_mfma_f32_32x32x16_bf16 v[128:143], v[8:11], v[0:3], v[128:143]
  v_mfma_f32_32x32x16_bf16 v[144:159], v[12:15], v[0:3], v[144:159]
  v_mfma_f32_32x32x16_bf16 v[160:175], v[16:19], v[0:3], v[160:175]
  v_mfma_f32_32x32x16_bf16 v[128:143], v[20:23], v[4:7], v[128:143]
  v_mfma_f32_32x32x16_bf16 v[144:159], v[24:27], v[4:7], v[144:159]
  v_mfma_f32_32x32x16_bf16 v[160:175], v[28:31], v[4:7], v[160:175]
  s_waitcnt lgkmcnt(0)
  s_barrier
  v_add_u32 v225, 0x10000, v225
  v_add_u32 v226, 0x10000, v226
  v_add_u32 v227, 0x10000, v227
  v_add_u32 v228, 0x10000, v228
  v_add_u32 v229, 0x10000, v229
  ds_read_b128 v[0:3], v225
  ds_read_b64_tr_b16 v[8:9], v227
  ds_read_b64_tr_b16 v[10:11], v227 offset:1024
  ds_read_b64_tr_b16 v[12:13], v228
  ds_read_b64_tr_b16 v[14:15], v228 offset:1024
  ds_read_b64_tr_b16 v[16:17], v229
  ds_read_b64_tr_b16 v[18:19], v229 offset:1024
  ds_read_b128 v[4:7], v226
  ds_read_b64_tr_b16 v[20:21], v227 offset:4096
  ds_read_b64_tr_b16 v[22:23], v227 offset:5120
  ds_read_b64_tr_b16 v[24:25], v228 offset:4096
  ds_read_b64_tr_b16 v[26:27], v228 offset:5120
  ds_read_b64_tr_b16 v[28:29], v229 offset:4096
  ds_read_b64_tr_b16 v[30:31], v229 offset:5120
  v_mfma_f32_32x32x16_bf16 v[128:143], v[40:43], v[32:35], v[128:143]
  v_mfma_f32_32x32x16_bf16 v[144:159], v[44:47], v[32:35], v[144:159]
  v_mfma_f32_32x32x16_bf16 v[160:175], v[48:51], v[32:35], v[160:175]
  v_mfma_f32_32x32x16_bf16 v[128:143], v[52:55], v[36:39], v[128:143]
  v_mfma_f32_32x32x16_bf16 v[144:159], v[56:59], v[36:39], v[144:159]
  v_mfma_f32_32x32x16_bf16 v[160:175], v[60:63], v[36:39], v[160:175]
  s_waitcnt lgkmcnt(0)
  s_barrier
  ds_read_b128 v[32:35], v225 offset:16384
  ds_read_b64_tr_b16 v[40:41], v227 offset:16384
  ds_read_b64_tr_b16 v[42:43], v227 offset:17408
  ds_read_b64_tr_b16 v[44:45], v228 offset:16384
  ds_read_b64_tr_b16 v[46:47], v228 offset:17408
  ds_read_b64_tr_b16 v[48:49], v229 offset:16384
  ds_read_b64_tr_b16 v[50:51], v229 offset:17408
  ds_read_b128 v[36:39], v226 offset:16384
  ds_read_b64_tr_b16 v[52:53], v227 offset:20480
  ds_read_b64_tr_b16 v[54:55], v227 offset:21504
  ds_read_b64_tr_b16 v[56:57], v228 offset:20480
  ds_read_b64_tr_b16 v[58:59], v228 offset:21504
  ds_read_b64_tr_b16 v[60:61], v229 offset:20480
  ds_read_b64_tr_b16 v[62:63], v229 offset:21504
  v_mfma_f32_32x32x16_bf16 v[128:143], v[8:11], v[0:3], v[128:143]
  v_mfma_f32_32x32x16_bf16 v[144:159], v[12:15], v[0:3], v[144:159]
  v_mfma_f32_32x32x16_bf16 v[160:175], v[16:19], v[0:3], v[160:175]
  v_mfma_f32_32x32x16_bf16 v[128:143], v[20:23], v[4:7], v[128:143]
  v_mfma_f32_32x32x16_bf16 v[144:159], v[24:27], v[4:7], v[144:159]
  v_mfma_f32_32x32x16_bf16 v[160:175], v[28:31], v[4:7], v[160:175]
  s_waitcnt lgkmcnt(0)
  v_mfma_f32_32x32x16_bf16 v[128:143], v[40:43], v[32:35], v[128:143]
  v_mfma_f32_32x32x16_bf16 v[144:159], v[44:47], v[32:35], v[144:159]
  v_mfma_f32_32x32x16_bf16 v[160:175], v[48:51], v[32:35], v[160:175]
  v_mfma_f32_32x32x16_bf16 v[128:143], v[52:55], v[36:39], v[128:143]
  v_mfma_f32_32x32x16_bf16 v[144:159], v[56:59], v[36:39], v[144:159]
  v_mfma_f32_32x32x16_bf16 v[160:175], v[60:63], v[36:39], v[160:175]
  s_lshl_b32 s29, s26, 13
  s_add_u32 s29, s29, 0x18000
  v_lshlrev_b32 v255, 4, v224
  v_add_u32 v255, s29, v255
  s_nop 5
  v_cvt_pk_bf16_f32 v0, v128, v129
  v_cvt_pk_bf16_f32 v1, v130, v131
  v_cvt_pk_bf16_f32 v2, v132, v133
  v_cvt_pk_bf16_f32 v3, v134, v135
  v_cvt_pk_bf16_f32 v4, v136, v137
  v_cvt_pk_bf16_f32 v5, v138, v139
  v_cvt_pk_bf16_f32 v6, v140, v141
  v_cvt_pk_bf16_f32 v7, v142, v143
  v_cvt_pk_bf16_f32 v8, v144, v145
  v_cvt_pk_bf16_f32 v9, v146, v147
  v_cvt_pk_bf16_f32 v10, v148, v149
  v_cvt_pk_bf16_f32 v11, v150, v151
  v_cvt_pk_bf16_f32 v12, v152, v153
  v_cvt_pk_bf16_f32 v13, v154, v155
  v_cvt_pk_bf16_f32 v14, v156, v157
  v_cvt_pk_bf16_f32 v15, v158, v159
  v_cvt_pk_bf16_f32 v16, v160, v161
  v_cvt_pk_bf16_f32 v17, v162, v163
  v_cvt_pk_bf16_f32 v18, v164, v165
  v_cvt_pk_bf16_f32 v19, v166, v167
  v_cvt_pk_bf16_f32 v20, v168, v169
  v_cvt_pk_bf16_f32 v21, v170, v171
  v_cvt_pk_bf16_f32 v22, v172, v173
  v_cvt_pk_bf16_f32 v23, v174, v175
  ds_write_b128 v255, v[0:3] offset:2048
  ds_write_b128 v255, v[4:7] offset:3072
  ds_write_b128 v255, v[8:11] offset:4096
  ds_write_b128 v255, v[12:15] offset:5120
  ds_write_b128 v255, v[16:19] offset:6144
  ds_write_b128 v255, v[20:23] offset:7168
  s_waitcnt lgkmcnt(0)
  s_barrier
  s_add_u32 m0, s31, 0xc000
  s_add_u32 s30, s31, 0xc000
  buffer_load_dwordx4 v230, s[12:15], s30 offen nt lds
  buffer_load_dwordx4 v231, s[12:15], s30 offen offset:1024 nt lds
  buffer_load_dwordx4 v232, s[12:15], s30 offen offset:2048 nt lds
  buffer_load_dwordx4 v233, s[12:15], s30 offen offset:3072 nt lds
  s_add_u32 m0, s31, 0x10000
  s_add_u32 s30, s31, 0x10000
  buffer_load_dwordx4 v230, s[12:15], s30 offen nt lds
  buffer_load_dwordx4 v231, s[12:15], s30 offen offset:1024 nt lds
  buffer_load_dwordx4 v232, s[12:15], s30 offen offset:2048 nt lds
  buffer_load_dwordx4 v233, s[12:15], s30 offen offset:3072 nt lds
  ds_read_b128 v[160:163], v255
  ds_read_b128 v[164:167], v255 offset:1024
  ds_read_b128 v[168:171], v255 offset:2048
  ds_read_b128 v[172:175], v255 offset:3072
  ds_read_b128 v[176:179], v255 offset:4096
  ds_read_b128 v[180:183], v255 offset:5120
  ds_read_b128 v[184:187], v255 offset:6144
  ds_read_b128 v[188:191], v255 offset:7168
  s_waitcnt lgkmcnt(0)
  s_barrier
  s_waitcnt vmcnt(16)
  s_barrier
  ds_read_b128 v[192:195], v235
  ds_read_b128 v[196:199], v236
  ds_read_b128 v[200:203], v237
  ds_read_b128 v[204:207], v238
  ds_read_b128 v[208:211], v239
  ds_read_b128 v[212:215], v240
  ds_read_b128 v[216:219], v241
  ds_read_b128 v[220:223], v242
  s_waitcnt lgkmcnt(0)
  s_waitcnt vmcnt(12)
  s_barrier
  v_mfma_f32_32x32x16_bf16 v[0:15], v[192:195], v[160:163], 0
  ds_read_b128 v[192:195], v235 offset:16384
  v_mfma_f32_32x32x16_bf16 v[0:15], v[196:199], v[164:167], v[0:15]
  ds_read_b128 v[196:199], v236 offset:16384
  v_mfma_f32_32x32x16_bf16 v[0:15], v[200:203], v[168:171], v[0:15]
  ds_read_b128 v[200:203], v237 offset:16384
  v_mfma_f32_32x32x16_bf16 v[0:15], v[204:207], v[172:175], v[0:15]
  ds_read_b128 v[204:207], v238 offset:16384
  v_mfma_f32_32x32x16_bf16 v[0:15], v[208:211], v[176:179], v[0:15]
  ds_read_b128 v[208:211], v239 offset:16384
  v_mfma_f32_32x32x16_bf16 v[0:15], v[212:215], v[180:183], v[0:15]
  ds_read_b128 v[212:215], v240 offset:16384
  v_mfma_f32_32x32x16_bf16 v[0:15], v[216:219], v[184:187], v[0:15]
  ds_read_b128 v[216:219], v241 offset:16384
  v_mfma_f32_32x32x16_bf16 v[0:15], v[220:223], v[188:191], v[0:15]
  ds_read_b128 v[220:223], v242 offset:16384
  s_add_u32 m0, s31, 0x14000
  s_add_u32 s30, s31, 0x14000
  buffer_load_dwordx4 v230, s[12:15], s30 offen nt lds
  buffer_load_dwordx4 v231, s[12:15], s30 offen offset:1024 nt lds
  buffer_load_dwordx4 v232, s[12:15], s30 offen offset:2048 nt lds
  buffer_load_dwordx4 v233, s[12:15], s30 offen offset:3072 nt lds
  s_waitcnt lgkmcnt(0)
  s_waitcnt vmcnt(12)
  s_barrier
  v_mfma_f32_32x32x16_bf16 v[16:31], v[192:195], v[160:163], 0
  ds_read_b128 v[192:195], v235 offset:32768
  v_max3_f32 v247, v0, v1, v2
  v_mfma_f32_32x32x16_bf16 v[16:31], v[196:199], v[164:167], v[16:31]
  ds_read_b128 v[196:199], v236 offset:32768
  v_max3_f32 v248, v3, v4, v5
  v_mfma_f32_32x32x16_bf16 v[16:31], v[200:203], v[168:171], v[16:31]
  ds_read_b128 v[200:203], v237 offset:32768
  v_max3_f32 v248, v248, v6, v7
  v_mfma_f32_32x32x16_bf16 v[16:31], v[204:207], v[172:175], v[16:31]
  ds_read_b128 v[204:207], v238 offset:32768
  v_max3_f32 v247, v247, v8, v9
  v_mfma_f32_32x32x16_bf16 v[16:31], v[208:211], v[176:179], v[16:31]
  ds_read_b128 v[208:211], v239 offset:32768
  v_max3_f32 v248, v248, v10, v11
  v_mfma_f32_32x32x16_bf16 v[16:31], v[212:215], v[180:183], v[16:31]
  ds_read_b128 v[212:215], v240 offset:32768
  v_max3_f32 v247, v247, v12, v13
  v_mfma_f32_32x32x16_bf16 v[16:31], v[216:219], v[184:187], v[16:31]
  ds_read_b128 v[216:219], v241 offset:32768
  v_max3_f32 v248, v248, v14, v15
  v_mfma_f32_32x32x16_bf16 v[16:31], v[220:223], v[188:191], v[16:31]
  ds_read_b128 v[220:223], v242 offset:32768
  s_add_u32 m0, s31, 0x20000
  s_add_u32 s30, s31, 0x18000
  buffer_load_dwordx4 v230, s[12:15], s30 offen nt lds
  buffer_load_dwordx4 v231, s[12:15], s30 offen offset:1024 nt lds
  buffer_load_dwordx4 v232, s[12:15], s30 offen offset:2048 nt lds
  buffer_load_dwordx4 v233, s[12:15], s30 offen offset:3072 nt lds
  s_waitcnt lgkmcnt(0)
  s_waitcnt vmcnt(12)
  s_barrier
  v_mfma_f32_32x32x16_bf16 v[32:47], v[192:195], v[160:163], 0
  ds_read_b128 v[192:195], v235 offset:49152
  v_max3_f32 v247, v247, v16, v17
  v_mfma_f32_32x32x16_bf16 v[32:47], v[196:199], v[164:167], v[32:47]
  ds_read_b128 v[196:199], v236 offset:49152
  v_max3_f32 v248, v248, v18, v19
  v_mfma_f32_32x32x16_bf16 v[32:47], v[200:203], v[168:171], v[32:47]
  ds_read_b128 v[200:203], v237 offset:49152
  v_max3_f32 v247, v247, v20, v21
  v_mfma_f32_32x32x16_bf16 v[32:47], v[204:207], v[172:175], v[32:47]
  ds_read_b128 v[204:207], v238 offset:49152
  v_max3_f32 v248, v248, v22, v23
  v_mfma_f32_32x32x16_bf16 v[32:47], v[208:211], v[176:179], v[32:47]
  ds_read_b128 v[208:211], v239 offset:49152
  v_max3_f32 v247, v247, v24, v25
  v_mfma_f32_32x32x16_bf16 v[32:47], v[212:215], v[180:183], v[32:47]
  ds_read_b128 v[212:215], v240 offset:49152
  v_max3_f32 v248, v248, v26, v27
  v_mfma_f32_32x32x16_bf16 v[32:47], v[216:219], v[184:187], v[32:47]
  ds_read_b128 v[216:219], v241 offset:49152
  v_max3_f32 v247, v247, v28, v29
  v_mfma_f32_32x32x16_bf16 v[32:47], v[220:223], v[188:191], v[32:47]
  ds_read_b128 v[220:223], v242 offset:49152
  v_max3_f32 v248, v248, v30, v31
  s_add_u32 m0, s31, 0x24000
  s_add_u32 s30, s31, 0x1c000
  buffer_load_dwordx4 v230, s[12:15], s30 offen nt lds
  buffer_load_dwordx4 v231, s[12:15], s30 offen offset:1024 nt lds
  buffer_load_dwordx4 v232, s[12:15], s30 offen offset:2048 nt lds
  buffer_load_dwordx4 v233, s[12:15], s30 offen offset:3072 nt lds
  s_waitcnt lgkmcnt(0)
  s_waitcnt vmcnt(12)
  s_barrier
  v_add_u32 v235, 0x10000, v235
  v_add_u32 v236, 0x10000, v236
  v_add_u32 v237, 0x10000, v237
  v_add_u32 v238, 0x10000, v238
  v_add_u32 v239, 0x10000, v239
  v_add_u32 v240, 0x10000, v240
  v_add_u32 v241, 0x10000, v241
  v_add_u32 v242, 0x10000, v242
  v_mfma_f32_32x32x16_bf16 v[48:63], v[192:195], v[160:163], 0
  ds_read_b128 v[192:195], v235
  v_max3_f32 v247, v247, v32, v33
  v_mfma_f32_32x32x16_bf16 v[48:63], v[196:199], v[164:167], v[48:63]
  ds_read_b128 v[196:199], v236
  v_max3_f32 v248, v248, v34, v35
  v_mfma_f32_32x32x16_bf16 v[48:63], v[200:203], v[168:171], v[48:63]
  ds_read_b128 v[200:203], v237
  v_max3_f32 v247, v247, v36, v37
  v_mfma_f32_32x32x16_bf16 v[48:63], v[204:207], v[172:175], v[48:63]
  ds_read_b128 v[204:207], v238
  v_max3_f32 v248, v248, v38, v39
  v_mfma_f32_32x32x16_bf16 v[48:63], v[208:211], v[176:179], v[48:63]
  ds_read_b128 v[208:211], v239
  v_max3_f32 v247, v247, v40, v41
  v_mfma_f32_32x32x16_bf16 v[48:63], v[212:215], v[180:183], v[48:63]
  ds_read_b128 v[212:215], v240
  v_max3_f32 v248, v248, v42, v43
  v_mfma_f32_32x32x16_bf16 v[48:63], v[216:219], v[184:187], v[48:63]
  ds_read_b128 v[216:219], v241
  v_max3_f32 v247, v247, v44, v45
  v_mfma_f32_32x32x16_bf16 v[48:63], v[220:223], v[188:191], v[48:63]
  ds_read_b128 v[220:223], v242
  v_max3_f32 v248, v248, v46, v47
  s_add_u32 m0, s31, 0x18000
  s_add_u32 s30, s31, 0
  buffer_load_dwordx4 v234, s[16:19], s30 offen nt lds
  buffer_load_dwordx4 v234, s[16:19], s30 offen offset:1024 nt lds
  buffer_load_dwordx4 v234, s[16:19], s30 offen offset:2048 nt lds
  buffer_load_dwordx4 v234, s[16:19], s30 offen offset:3072 nt lds
  s_waitcnt lgkmcnt(0)
  s_waitcnt vmcnt(12)
  s_barrier
  v_mfma_f32_32x32x16_bf16 v[64:79], v[192:195], v[160:163], 0
  ds_read_b128 v[192:195], v235 offset:16384
  v_max3_f32 v247, v247, v48, v49
  v_mfma_f32_32x32x16_bf16 v[64:79], v[196:199], v[164:167], v[64:79]
  ds_read_b128 v[196:199], v236 offset:16384
  v_max3_f32 v248, v248, v50, v51
  v_mfma_f32_32x32x16_bf16 v[64:79], v[200:203], v[168:171], v[64:79]
  ds_read_b128 v[200:203], v237 offset:16384
  v_max3_f32 v247, v247, v52, v53
  v_mfma_f32_32x32x16_bf16 v[64:79], v[204:207], v[172:175], v[64:79]
  ds_read_b128 v[204:207], v238 offset:16384
  v_max3_f32 v248, v248, v54, v55
  v_mfma_f32_32x32x16_bf16 v[64:79], v[208:211], v[176:179], v[64:79]
  ds_read_b128 v[208:211], v239 offset:16384
  v_max3_f32 v247, v247, v56, v57
  v_mfma_f32_32x32x16_bf16 v[64:79], v[212:215], v[180:183], v[64:79]
  ds_read_b128 v[212:215], v240 offset:16384
  v_max3_f32 v248, v248, v58, v59
  v_mfma_f32_32x32x16_bf16 v[64:79], v[216:219], v[184:187], v[64:79]
  ds_read_b128 v[216:219], v241 offset:16384
  v_max3_f32 v247, v247, v60, v61
  v_mfma_f32_32x32x16_bf16 v[64:79], v[220:223], v[188:191], v[64:79]
  ds_read_b128 v[220:223], v242 offset:16384
  v_max3_f32 v248, v248, v62, v63
  s_add_u32 m0, s31, 0x1c000
  s_add_u32 s30, s31, 0x4000
  buffer_load_dwordx4 v234, s[16:19], s30 offen nt lds
  buffer_load_dwordx4 v234, s[16:19], s30 offen offset:1024 nt lds
  buffer_load_dwordx4 v234, s[16:19], s30 offen offset:2048 nt lds
  buffer_load_dwordx4 v234, s[16:19], s30 offen offset:3072 nt lds
  s_waitcnt lgkmcnt(0)
  s_waitcnt vmcnt(12)
  s_barrier
  v_add_u32 v235, 0x10000, v235
  v_add_u32 v236, 0x10000, v236
  v_add_u32 v237, 0x10000, v237
  v_add_u32 v238, 0x10000, v238
  v_add_u32 v239, 0x10000, v239
  v_add_u32 v240, 0x10000, v240
  v_add_u32 v241, 0x10000, v241
  v_add_u32 v242, 0x10000, v242
  v_mfma_f32_32x32x16_bf16 v[80:95], v[192:195], v[160:163], 0
  ds_read_b128 v[192:195], v235
  v_max3_f32 v247, v247, v64, v65
  v_mfma_f32_32x32x16_bf16 v[80:95], v[196:199], v[164:167], v[80:95]
  ds_read_b128 v[196:199], v236
  v_max3_f32 v248, v248, v66, v67
  v_mfma_f32_32x32x16_bf16 v[80:95], v[200:203], v[168:171], v[80:95]
  ds_read_b128 v[200:203], v237
  v_max3_f32 v247, v247, v68, v69
  v_mfma_f32_32x32x16_bf16 v[80:95], v[204:207], v[172:175], v[80:95]
  ds_read_b128 v[204:207], v238
  v_max3_f32 v248, v248, v70, v71
  v_mfma_f32_32x32x16_bf16 v[80:95], v[208:211], v[176:179], v[80:95]
  ds_read_b128 v[208:211], v239
  v_max3_f32 v247, v247, v72, v73
  v_mfma_f32_32x32x16_bf16 v[80:95], v[212:215], v[180:183], v[80:95]
  ds_read_b128 v[212:215], v240
  v_max3_f32 v248, v248, v74, v75
  v_mfma_f32_32x32x16_bf16 v[80:95], v[216:219], v[184:187], v[80:95]
  ds_read_b128 v[216:219], v241
  v_max3_f32 v247, v247, v76, v77
  v_mfma_f32_32x32x16_bf16 v[80:95], v[220:223], v[188:191], v[80:95]
  ds_read_b128 v[220:223], v242
  v_max3_f32 v248, v248, v78, v79
  s_add_u32 m0, s31, 0
  s_add_u32 s30, s31, 0x8000
  buffer_load_dwordx4 v234, s[16:19], s30 offen nt lds
  buffer_load_dwordx4 v234, s[16:19], s30 offen offset:1024 nt lds
  buffer_load_dwordx4 v234, s[16:19], s30 offen offset:2048 nt lds
  buffer_load_dwordx4 v234, s[16:19], s30 offen offset:3072 nt lds
  s_waitcnt lgkmcnt(0)
  s_waitcnt vmcnt(12)
  s_barrier
  v_mfma_f32_32x32x16_bf16 v[96:111], v[192:195], v[160:163], 0
  ds_read_b128 v[192:195], v235 offset:16384
  v_max3_f32 v247, v247, v80, v81
  v_mfma_f32_32x32x16_bf16 v[96:111], v[196:199], v[164:167], v[96:111]
  ds_read_b128 v[196:199], v236 offset:16384
  v_max3_f32 v248, v248, v82, v83
  v_mfma_f32_32x32x16_bf16 v[96:111], v[200:203], v[168:171], v[96:111]
  ds_read_b128 v[200:203], v237 offset:16384
  v_max3_f32 v247, v247, v84, v85
  v_mfma_f32_32x32x16_bf16 v[96:111], v[204:207], v[172:175], v[96:111]
  ds_read_b128 v[204:207], v238 offset:16384
  v_max3_f32 v248, v248, v86, v87
  v_mfma_f32_32x32x16_bf16 v[96:111], v[208:211], v[176:179], v[96:111]
  ds_read_b128 v[208:211], v239 offset:16384
  v_max3_f32 v247, v247, v88, v89
  v_mfma_f32_32x32x16_bf16 v[96:111], v[212:215], v[180:183], v[96:111]
  ds_read_b128 v[212:215], v240 offset:16384
  v_max3_f32 v248, v248, v90, v91
  v_mfma_f32_32x32x16_bf16 v[96:111], v[216:219], v[184:187], v[96:111]
  ds_read_b128 v[216:219], v241 offset:16384
  v_max3_f32 v247, v247, v92, v93
  v_mfma_f32_32x32x16_bf16 v[96:111], v[220:223], v[188:191], v[96:111]
  ds_read_b128 v[220:223], v242 offset:16384
  v_max3_f32 v248, v248, v94, v95
  s_add_u32 m0, s31, 0x4000
  s_add_u32 s30, s31, 0xc000
  buffer_load_dwordx4 v234, s[16:19], s30 offen nt lds
  buffer_load_dwordx4 v234, s[16:19], s30 offen offset:1024 nt lds
  buffer_load_dwordx4 v234, s[16:19], s30 offen offset:2048 nt lds
  buffer_load_dwordx4 v234, s[16:19], s30 offen offset:3072 nt lds
  s_waitcnt lgkmcnt(0)
  s_waitcnt vmcnt(12)
  s_barrier
  v_add_u32 v243, 0x10000, v243
  v_add_u32 v244, 0x10000, v244
  v_add_u32 v245, 0x10000, v245
  v_add_u32 v246, 0x10000, v246
  v_mfma_f32_32x32x16_bf16 v[112:127], v[192:195], v[160:163], 0
  ds_read_b64_tr_b16 v[192:193], v243 offset:32768
  ds_read_b64_tr_b16 v[194:195], v243 offset:34816
  v_max3_f32 v247, v247, v96, v97
  v_mfma_f32_32x32x16_bf16 v[112:127], v[196:199], v[164:167], v[112:127]
  ds_read_b64_tr_b16 v[196:197], v244 offset:32768
  ds_read_b64_tr_b16 v[198:199], v244 offset:34816
  v_max3_f32 v248, v248, v98, v99
  v_mfma_f32_32x32x16_bf16 v[112:127], v[200:203], v[168:171], v[112:127]
  ds_read_b64_tr_b16 v[200:201], v245 offset:32768
  ds_read_b64_tr_b16 v[202:203], v245 offset:34816
  v_max3_f32 v247, v247, v100, v101
  v_mfma_f32_32x32x16_bf16 v[112:127], v[204:207], v[172:175], v[112:127]
  ds_read_b64_tr_b16 v[204:205], v246 offset:32768
  ds_read_b64_tr_b16 v[206:207], v246 offset:34816
  v_max3_f32 v248, v248, v102, v103
  v_mfma_f32_32x32x16_bf16 v[112:127], v[208:211], v[176:179], v[112:127]
  ds_read_b64_tr_b16 v[208:209], v243 offset:36864
  ds_read_b64_tr_b16 v[210:211], v243 offset:38912
  v_max3_f32 v247, v247, v104, v105
  v_mfma_f32_32x32x16_bf16 v[112:127], v[212:215], v[180:183], v[112:127]
  ds_read_b64_tr_b16 v[212:213], v244 offset:36864
  ds_read_b64_tr_b16 v[214:215], v244 offset:38912
  v_max3_f32 v248, v248, v106, v107
  v_mfma_f32_32x32x16_bf16 v[112:127], v[216:219], v[184:187], v[112:127]
  ds_read_b64_tr_b16 v[216:217], v245 offset:36864
  ds_read_b64_tr_b16 v[218:219], v245 offset:38912
  v_max3_f32 v247, v247, v108, v109
  v_mfma_f32_32x32x16_bf16 v[112:127], v[220:223], v[188:191], v[112:127]
  ds_read_b64_tr_b16 v[220:221], v246 offset:36864
  ds_read_b64_tr_b16 v[222:223], v246 offset:38912
  v_max3_f32 v248, v248, v110, v111
  s_add_u32 m0, s31, 0x8000
  s_add_u32 s30, s31, 0x10000
  buffer_load_dwordx4 v234, s[16:19], s30 offen nt lds
  buffer_load_dwordx4 v234, s[16:19], s30 offen offset:1024 nt lds
  buffer_load_dwordx4 v234, s[16:19], s30 offen offset:2048 nt lds
  buffer_load_dwordx4 v234, s[16:19], s30 offen offset:3072 nt lds
  s_nop 2
  v_max3_f32 v247, v247, v112, v113
  v_max3_f32 v248, v248, v114, v115
  v_max3_f32 v247, v247, v116, v117
  v_max3_f32 v248, v248, v118, v119
  v_max3_f32 v247, v247, v120, v121
  v_max3_f32 v248, v248, v122, v123
  v_max3_f32 v247, v247, v124, v125
  v_max3_f32 v248, v248, v126, v127
  v_max_f32 v247, v247, v248
  v_mov_b32 v250, v247
  s_nop 1
  v_permlane32_swap_b32 v247, v250
  v_max_f32 v247, v247, v250
  v_mul_f32 v249, s32, v247
  v_sub_f32 v249, 0, v249
  v_fma_f32 v0, v0, s32, v249
  v_fma_f32 v1, v1, s32, v249
  v_exp_f32 v0, v0
  v_exp_f32 v1, v1
  v_mov_b32 v248, v0
  v_mov_b32 v253, v1
  v_cvt_pk_bf16_f32 v0, v0, v1
  v_fma_f32 v2, v2, s32, v249
  v_fma_f32 v3, v3, s32, v249
  v_exp_f32 v2, v2
  v_exp_f32 v3, v3
  v_add_f32 v248, v248, v2
  v_add_f32 v253, v253, v3
  v_cvt_pk_bf16_f32 v1, v2, v3
  v_fma_f32 v4, v4, s32, v249
  v_fma_f32 v5, v5, s32, v249
  v_exp_f32 v4, v4
  v_exp_f32 v5, v5
  v_add_f32 v248, v248, v4
  v_add_f32 v253, v253, v5
  v_cvt_pk_bf16_f32 v2, v4, v5
  v_fma_f32 v6, v6, s32, v249
  v_fma_f32 v7, v7, s32, v249
  v_exp_f32 v6, v6
  v_exp_f32 v7, v7
  v_add_f32 v248, v248, v6
  v_add_f32 v253, v253, v7
  v_cvt_pk_bf16_f32 v3, v6, v7
  v_fma_f32 v8, v8, s32, v249
  v_fma_f32 v9, v9, s32, v249
  v_exp_f32 v8, v8
  v_exp_f32 v9, v9
  v_add_f32 v248, v248, v8
  v_add_f32 v253, v253, v9
  v_cvt_pk_bf16_f32 v4, v8, v9
  v_fma_f32 v10, v10, s32, v249
  v_fma_f32 v11, v11, s32, v249
  v_exp_f32 v10, v10
  v_exp_f32 v11, v11
  v_add_f32 v248, v248, v10
  v_add_f32 v253, v253, v11
  v_cvt_pk_bf16_f32 v5, v10, v11
  v_fma_f32 v12, v12, s32, v249
  v_fma_f32 v13, v13, s32, v249
  v_exp_f32 v12, v12
  v_exp_f32 v13, v13
  v_add_f32 v248, v248, v12
  v_add_f32 v253, v253, v13
  v_cvt_pk_bf16_f32 v6, v12, v13
  v_fma_f32 v14, v14, s32, v249
  v_fma_f32 v15, v15, s32, v249
  v_exp_f32 v14, v14
  v_exp_f32 v15, v15
  v_add_f32 v248, v248, v14
  v_add_f32 v253, v253, v15
  v_cvt_pk_bf16_f32 v7, v14, v15
  s_waitcnt lgkmcnt(0)
  s_waitcnt vmcnt(12)
  s_barrier
  v_mfma_f32_32x32x16_bf16 v[128:143], v[192:195], v[0:3], 0
  ds_read_b64_tr_b16 v[192:193], v243 offset:49152
  ds_read_b64_tr_b16 v[194:195], v243 offset:51200
  v_fma_f32 v16, v16, s32, v249
  v_fma_f32 v17, v17, s32, v249
  v_exp_f32 v16, v16
  v_exp_f32 v17, v17
  v_add_f32 v248, v248, v16
  v_add_f32 v253, v253, v17
  v_cvt_pk_bf16_f32 v16, v16, v17
  v_mfma_f32_32x32x16_bf16 v[144:159], v[196:199], v[0:3], 0
  ds_read_b64_tr_b16 v[196:197], v244 offset:49152
  ds_read_b64_tr_b16 v[198:199], v244 offset:51200
  v_fma_f32 v18, v18, s32, v249
  v_fma_f32 v19, v19, s32, v249
  v_exp_f32 v18, v18
  v_exp_f32 v19, v19
  v_add_f32 v248, v248, v18
  v_add_f32 v253, v253, v19
  v_cvt_pk_bf16_f32 v17, v18, v19
  v_mfma_f32_32x32x16_bf16 v[160:175], v[200:203], v[0:3], 0
  ds_read_b64_tr_b16 v[200:201], v245 offset:49152
  ds_read_b64_tr_b16 v[202:203], v245 offset:51200
  v_fma_f32 v20, v20, s32, v249
  v_fma_f32 v21, v21, s32, v249
  v_exp_f32 v20, v20
  v_exp_f32 v21, v21
  v_add_f32 v248, v248, v20
  v_add_f32 v253, v253, v21
  v_cvt_pk_bf16_f32 v18, v20, v21
  v_mfma_f32_32x32x16_bf16 v[176:191], v[204:207], v[0:3], 0
  ds_read_b64_tr_b16 v[204:205], v246 offset:49152
  ds_read_b64_tr_b16 v[206:207], v246 offset:51200
  v_fma_f32 v22, v22, s32, v249
  v_fma_f32 v23, v23, s32, v249
  v_exp_f32 v22, v22
  v_exp_f32 v23, v23
  v_add_f32 v248, v248, v22
  v_add_f32 v253, v253, v23
  v_cvt_pk_bf16_f32 v19, v22, v23
  v_mfma_f32_32x32x16_bf16 v[128:143], v[208:211], v[4:7], v[128:143]
  ds_read_b64_tr_b16 v[208:209], v243 offset:53248
  ds_read_b64_tr_b16 v[210:211], v243 offset:55296
  v_fma_f32 v24, v24, s32, v249
  v_fma_f32 v25, v25, s32, v249
  v_exp_f32 v24, v24
  v_exp_f32 v25, v25
  v_add_f32 v248, v248, v24
  v_add_f32 v253, v253, v25
  v_cvt_pk_bf16_f32 v20, v24, v25
  v_mfma_f32_32x32x16_bf16 v[144:159], v[212:215], v[4:7], v[144:159]
  ds_read_b64_tr_b16 v[212:213], v244 offset:53248
  ds_read_b64_tr_b16 v[214:215], v244 offset:55296
  v_fma_f32 v26, v26, s32, v249
  v_fma_f32 v27, v27, s32, v249
  v_exp_f32 v26, v26
  v_exp_f32 v27, v27
  v_add_f32 v248, v248, v26
  v_add_f32 v253, v253, v27
  v_cvt_pk_bf16_f32 v21, v26, v27
  v_mfma_f32_32x32x16_bf16 v[160:175], v[216:219], v[4:7], v[160:175]
  ds_read_b64_tr_b16 v[216:217], v245 offset:53248
  ds_read_b64_tr_b16 v[218:219], v245 offset:55296
  v_fma_f32 v28, v28, s32, v249
  v_fma_f32 v29, v29, s32, v249
  v_exp_f32 v28, v28
  v_exp_f32 v29, v29
  v_add_f32 v248, v248, v28
  v_add_f32 v253, v253, v29
  v_cvt_pk_bf16_f32 v22, v28, v29
  v_mfma_f32_32x32x16_bf16 v[176:191], v[220:223], v[4:7], v[176:191]
  ds_read_b64_tr_b16 v[220:221], v246 offset:53248
  ds_read_b64_tr_b16 v[222:223], v246 offset:55296
  v_fma_f32 v30, v30, s32, v249
  v_fma_f32 v31, v31, s32, v249
  v_exp_f32 v30, v30
  v_exp_f32 v31, v31
  v_add_f32 v248, v248, v30
  v_add_f32 v253, v253, v31
  v_cvt_pk_bf16_f32 v23, v30, v31
  s_add_u32 m0, s31, 0xc000
  s_add_u32 s30, s31, 0x14000
  buffer_load_dwordx4 v234, s[16:19], s30 offen nt lds
  buffer_load_dwordx4 v234, s[16:19], s30 offen offset:1024 nt lds
  buffer_load_dwordx4 v234, s[16:19], s30 offen offset:2048 nt lds
  buffer_load_dwordx4 v234, s[16:19], s30 offen offset:3072 nt lds
  s_waitcnt lgkmcnt(0)
  s_waitcnt vmcnt(12)
  s_barrier
  v_add_u32 v243, 0xffff0000, v243
  v_add_u32 v244, 0xffff0000, v244
  v_add_u32 v245, 0xffff0000, v245
  v_add_u32 v246, 0xffff0000, v246
  v_mfma_f32_32x32x16_bf16 v[128:143], v[192:195], v[16:19], v[128:143]
  ds_read_b64_tr_b16 v[192:193], v243
  ds_read_b64_tr_b16 v[194:195], v243 offset:2048
  v_fma_f32 v32, v32, s32, v249
  v_fma_f32 v33, v33, s32, v249
  v_exp_f32 v32, v32
  v_exp_f32 v33, v33
  v_add_f32 v248, v248, v32
  v_add_f32 v253, v253, v33
  v_cvt_pk_bf16_f32 v32, v32, v33
  v_mfma_f32_32x32x16_bf16 v[144:159], v[196:199], v[16:19], v[144:159]
  ds_read_b64_tr_b16 v[196:197], v244
  ds_read_b64_tr_b16 v[198:199], v244 offset:2048
  v_fma_f32 v34, v34, s32, v249
  v_fma_f32 v35, v35, s32, v249
  v_exp_f32 v34, v34
  v_exp_f32 v35, v35
  v_add_f32 v248, v248, v34
  v_add_f32 v253, v253, v35
  v_cvt_pk_bf16_f32 v33, v34, v35
  v_mfma_f32_32x32x16_bf16 v[160:175], v[200:203], v[16:19], v[160:175]
  ds_read_b64_tr_b16 v[200:201], v245
  ds_read_b64_tr_b16 v[202:203], v245 offset:2048
  v_fma_f32 v36, v36, s32, v249
  v_fma_f32 v37, v37, s32, v249
  v_exp_f32 v36, v36
  v_exp_f32 v37, v37
  v_add_f32 v248, v248, v36
  v_add_f32 v253, v253, v37
  v_cvt_pk_bf16_f32 v34, v36, v37
  v_mfma_f32_32x32x16_bf16 v[176:191], v[204:207], v[16:19], v[176:191]
  ds_read_b64_tr_b16 v[204:205], v246
  ds_read_b64_tr_b16 v[206:207], v246 offset:2048
  v_fma_f32 v38, v38, s32, v249
  v_fma_f32 v39, v39, s32, v249
  v_exp_f32 v38, v38
  v_exp_f32 v39, v39
  v_add_f32 v248, v248, v38
  v_add_f32 v253, v253, v39
  v_cvt_pk_bf16_f32 v35, v38, v39
  v_mfma_f32_32x32x16_bf16 v[128:143], v[208:211], v[20:23], v[128:143]
  ds_read_b64_tr_b16 v[208:209], v243 offset:4096
  ds_read_b64_tr_b16 v[210:211], v243 offset:6144
  v_fma_f32 v40, v40, s32, v249
  v_fma_f32 v41, v41, s32, v249
  v_exp_f32 v40, v40
  v_exp_f32 v41, v41
  v_add_f32 v248, v248, v40
  v_add_f32 v253, v253, v41
  v_cvt_pk_bf16_f32 v36, v40, v41
  v_mfma_f32_32x32x16_bf16 v[144:159], v[212:215], v[20:23], v[144:159]
  ds_read_b64_tr_b16 v[212:213], v244 offset:4096
  ds_read_b64_tr_b16 v[214:215], v244 offset:6144
  v_fma_f32 v42, v42, s32, v249
  v_fma_f32 v43, v43, s32, v249
  v_exp_f32 v42, v42
  v_exp_f32 v43, v43
  v_add_f32 v248, v248, v42
  v_add_f32 v253, v253, v43
  v_cvt_pk_bf16_f32 v37, v42, v43
  v_mfma_f32_32x32x16_bf16 v[160:175], v[216:219], v[20:23], v[160:175]
  ds_read_b64_tr_b16 v[216:217], v245 offset:4096
  ds_read_b64_tr_b16 v[218:219], v245 offset:6144
  v_fma_f32 v44, v44, s32, v249
  v_fma_f32 v45, v45, s32, v249
  v_exp_f32 v44, v44
  v_exp_f32 v45, v45
  v_add_f32 v248, v248, v44
  v_add_f32 v253, v253, v45
  v_cvt_pk_bf16_f32 v38, v44, v45
  v_mfma_f32_32x32x16_bf16 v[176:191], v[220:223], v[20:23], v[176:191]
  ds_read_b64_tr_b16 v[220:221], v246 offset:4096
  ds_read_b64_tr_b16 v[222:223], v246 offset:6144
  v_fma_f32 v46, v46, s32, v249
  v_fma_f32 v47, v47, s32, v249
  v_exp_f32 v46, v46
  v_exp_f32 v47, v47
  v_add_f32 v248, v248, v46
  v_add_f32 v253, v253, v47
  v_cvt_pk_bf16_f32 v39, v46, v47
  s_add_u32 m0, s31, 0x10000
  s_add_u32 s30, s31, 0x18000
  buffer_load_dwordx4 v234, s[16:19], s30 offen nt lds
  buffer_load_dwordx4 v234, s[16:19], s30 offen offset:1024 nt lds
  buffer_load_dwordx4 v234, s[16:19], s30 offen offset:2048 nt lds
  buffer_load_dwordx4 v234, s[16:19], s30 offen offset:3072 nt lds
  s_waitcnt lgkmcnt(0)
  s_waitcnt vmcnt(12)
  s_barrier
  v_mfma_f32_32x32x16_bf16 v[128:143], v[192:195], v[32:35], v[128:143]
  ds_read_b64_tr_b16 v[192:193], v243 offset:16384
  ds_read_b64_tr_b16 v[194:195], v243 offset:18432
  v_fma_f32 v48, v48, s32, v249
  v_fma_f32 v49, v49, s32, v249
  v_exp_f32 v48, v48
  v_exp_f32 v49, v49
  v_add_f32 v248, v248, v48
  v_add_f32 v253, v253, v49
  v_cvt_pk_bf16_f32 v48, v48, v49
  v_mfma_f32_32x32x16_bf16 v[144:159], v[196:199], v[32:35], v[144:159]
  ds_read_b64_tr_b16 v[196:197], v244 offset:16384
  ds_read_b64_tr_b16 v[198:199], v244 offset:18432
  v_fma_f32 v50, v50, s32, v249
  v_fma_f32 v51, v51, s32, v249
  v_exp_f32 v50, v50
  v_exp_f32 v51, v51
  v_add_f32 v248, v248, v50
  v_add_f32 v253, v253, v51
  v_cvt_pk_bf16_f32 v49, v50, v51
  v_mfma_f32_32x32x16_bf16 v[160:175], v[200:203], v[32:35], v[160:175]
  ds_read_b64_tr_b16 v[200:201], v245 offset:16384
  ds_read_b64_tr_b16 v[202:203], v245 offset:18432
  v_fma_f32 v52, v52, s32, v249
  v_fma_f32 v53, v53, s32, v249
  v_exp_f32 v52, v52
  v_exp_f32 v53, v53
  v_add_f32 v248, v248, v52
  v_add_f32 v253, v253, v53
  v_cvt_pk_bf16_f32 v50, v52, v53
  v_mfma_f32_32x32x16_bf16 v[176:191], v[204:207], v[32:35], v[176:191]
  ds_read_b64_tr_b16 v[204:205], v246 offset:16384
  ds_read_b64_tr_b16 v[206:207], v246 offset:18432
  v_fma_f32 v54, v54, s32, v249
  v_fma_f32 v55, v55, s32, v249
  v_exp_f32 v54, v54
  v_exp_f32 v55, v55
  v_add_f32 v248, v248, v54
  v_add_f32 v253, v253, v55
  v_cvt_pk_bf16_f32 v51, v54, v55
  v_mfma_f32_32x32x16_bf16 v[128:143], v[208:211], v[36:39], v[128:143]
  ds_read_b64_tr_b16 v[208:209], v243 offset:20480
  ds_read_b64_tr_b16 v[210:211], v243 offset:22528
  v_fma_f32 v56, v56, s32, v249
  v_fma_f32 v57, v57, s32, v249
  v_exp_f32 v56, v56
  v_exp_f32 v57, v57
  v_add_f32 v248, v248, v56
  v_add_f32 v253, v253, v57
  v_cvt_pk_bf16_f32 v52, v56, v57
  v_mfma_f32_32x32x16_bf16 v[144:159], v[212:215], v[36:39], v[144:159]
  ds_read_b64_tr_b16 v[212:213], v244 offset:20480
  ds_read_b64_tr_b16 v[214:215], v244 offset:22528
  v_fma_f32 v58, v58, s32, v249
  v_fma_f32 v59, v59, s32, v249
  v_exp_f32 v58, v58
  v_exp_f32 v59, v59
  v_add_f32 v248, v248, v58
  v_add_f32 v253, v253, v59
  v_cvt_pk_bf16_f32 v53, v58, v59
  v_mfma_f32_32x32x16_bf16 v[160:175], v[216:219], v[36:39], v[160:175]
  ds_read_b64_tr_b16 v[216:217], v245 offset:20480
  ds_read_b64_tr_b16 v[218:219], v245 offset:22528
  v_fma_f32 v60, v60, s32, v249
  v_fma_f32 v61, v61, s32, v249
  v_exp_f32 v60, v60
  v_exp_f32 v61, v61
  v_add_f32 v248, v248, v60
  v_add_f32 v253, v253, v61
  v_cvt_pk_bf16_f32 v54, v60, v61
  v_mfma_f32_32x32x16_bf16 v[176:191], v[220:223], v[36:39], v[176:191]
  ds_read_b64_tr_b16 v[220:221], v246 offset:20480
  ds_read_b64_tr_b16 v[222:223], v246 offset:22528
  v_fma_f32 v62, v62, s32, v249
  v_fma_f32 v63, v63, s32, v249
  v_exp_f32 v62, v62
  v_exp_f32 v63, v63
  v_add_f32 v248, v248, v62
  v_add_f32 v253, v253, v63
  v_cvt_pk_bf16_f32 v55, v62, v63
  s_add_u32 m0, s31, 0x14000
  s_add_u32 s30, s31, 0x1c000
  buffer_load_dwordx4 v234, s[16:19], s30 offen nt lds
  buffer_load_dwordx4 v234, s[16:19], s30 offen offset:1024 nt lds
  buffer_load_dwordx4 v234, s[16:19], s30 offen offset:2048 nt lds
  buffer_load_dwordx4 v234, s[16:19], s30 offen offset:3072 nt lds
  s_waitcnt lgkmcnt(0)
  s_waitcnt vmcnt(12)
  s_barrier
  v_mfma_f32_32x32x16_bf16 v[128:143], v[192:195], v[48:51], v[128:143]
  ds_read_b64_tr_b16 v[192:193], v243 offset:32768
  ds_read_b64_tr_b16 v[194:195], v243 offset:34816
  v_fma_f32 v64, v64, s32, v249
  v_fma_f32 v65, v65, s32, v249
  v_exp_f32 v64, v64
  v_exp_f32 v65, v65
  v_add_f32 v248, v248, v64
  v_add_f32 v253, v253, v65
  v_cvt_pk_bf16_f32 v64, v64, v65
  v_mfma_f32_32x32x16_bf16 v[144:159], v[196:199], v[48:51], v[144:159]
  ds_read_b64_tr_b16 v[196:197], v244 offset:32768
  ds_read_b64_tr_b16 v[198:199], v244 offset:34816
  v_fma_f32 v66, v66, s32, v249
  v_fma_f32 v67, v67, s32, v249
  v_exp_f32 v66, v66
  v_exp_f32 v67, v67
  v_add_f32 v248, v248, v66
  v_add_f32 v253, v253, v67
  v_cvt_pk_bf16_f32 v65, v66, v67
  v_mfma_f32_32x32x16_bf16 v[160:175], v[200:203], v[48:51], v[160:175]
  ds_read_b64_tr_b16 v[200:201], v245 offset:32768
  ds_read_b64_tr_b16 v[202:203], v245 offset:34816
  v_fma_f32 v68, v68, s32, v249
  v_fma_f32 v69, v69, s32, v249
  v_exp_f32 v68, v68
  v_exp_f32 v69, v69
  v_add_f32 v248, v248, v68
  v_add_f32 v253, v253, v69
  v_cvt_pk_bf16_f32 v66, v68, v69
  v_mfma_f32_32x32x16_bf16 v[176:191], v[204:207], v[48:51], v[176:191]
  ds_read_b64_tr_b16 v[204:205], v246 offset:32768
  ds_read_b64_tr_b16 v[206:207], v246 offset:34816
  v_fma_f32 v70, v70, s32, v249
  v_fma_f32 v71, v71, s32, v249
  v_exp_f32 v70, v70
  v_exp_f32 v71, v71
  v_add_f32 v248, v248, v70
  v_add_f32 v253, v253, v71
  v_cvt_pk_bf16_f32 v67, v70, v71
  v_mfma_f32_32x32x16_bf16 v[128:143], v[208:211], v[52:55], v[128:143]
  ds_read_b64_tr_b16 v[208:209], v243 offset:36864
  ds_read_b64_tr_b16 v[210:211], v243 offset:38912
  v_fma_f32 v72, v72, s32, v249
  v_fma_f32 v73, v73, s32, v249
  v_exp_f32 v72, v72
  v_exp_f32 v73, v73
  v_add_f32 v248, v248, v72
  v_add_f32 v253, v253, v73
  v_cvt_pk_bf16_f32 v68, v72, v73
  v_mfma_f32_32x32x16_bf16 v[144:159], v[212:215], v[52:55], v[144:159]
  ds_read_b64_tr_b16 v[212:213], v244 offset:36864
  ds_read_b64_tr_b16 v[214:215], v244 offset:38912
  v_fma_f32 v74, v74, s32, v249
  v_fma_f32 v75, v75, s32, v249
  v_exp_f32 v74, v74
  v_exp_f32 v75, v75
  v_add_f32 v248, v248, v74
  v_add_f32 v253, v253, v75
  v_cvt_pk_bf16_f32 v69, v74, v75
  v_mfma_f32_32x32x16_bf16 v[160:175], v[216:219], v[52:55], v[160:175]
  ds_read_b64_tr_b16 v[216:217], v245 offset:36864
  ds_read_b64_tr_b16 v[218:219], v245 offset:38912
  v_fma_f32 v76, v76, s32, v249
  v_fma_f32 v77, v77, s32, v249
  v_exp_f32 v76, v76
  v_exp_f32 v77, v77
  v_add_f32 v248, v248, v76
  v_add_f32 v253, v253, v77
  v_cvt_pk_bf16_f32 v70, v76, v77
  v_mfma_f32_32x32x16_bf16 v[176:191], v[220:223], v[52:55], v[176:191]
  ds_read_b64_tr_b16 v[220:221], v246 offset:36864
  ds_read_b64_tr_b16 v[222:223], v246 offset:38912
  v_fma_f32 v78, v78, s32, v249
  v_fma_f32 v79, v79, s32, v249
  v_exp_f32 v78, v78
  v_exp_f32 v79, v79
  v_add_f32 v248, v248, v78
  v_add_f32 v253, v253, v79
  v_cvt_pk_bf16_f32 v71, v78, v79
  s_waitcnt lgkmcnt(0)
  s_waitcnt vmcnt(8)
  s_barrier
  v_mfma_f32_32x32x16_bf16 v[128:143], v[192:195], v[64:67], v[128:143]
  ds_read_b64_tr_b16 v[192:193], v243 offset:49152
  ds_read_b64_tr_b16 v[194:195], v243 offset:51200
  v_fma_f32 v80, v80, s32, v249
  v_fma_f32 v81, v81, s32, v249
  v_exp_f32 v80, v80
  v_exp_f32 v81, v81
  v_add_f32 v248, v248, v80
  v_add_f32 v253, v253, v81
  v_cvt_pk_bf16_f32 v80, v80, v81
  v_mfma_f32_32x32x16_bf16 v[144:159], v[196:199], v[64:67], v[144:159]
  ds_read_b64_tr_b16 v[196:197], v244 offset:49152
  ds_read_b64_tr_b16 v[198:199], v244 offset:51200
  v_fma_f32 v82, v82, s32, v249
  v_fma_f32 v83, v83, s32, v249
  v_exp_f32 v82, v82
  v_exp_f32 v83, v83
  v_add_f32 v248, v248, v82
  v_add_f32 v253, v253, v83
  v_cvt_pk_bf16_f32 v81, v82, v83
  v_mfma_f32_32x32x16_bf16 v[160:175], v[200:203], v[64:67], v[160:175]
  ds_read_b64_tr_b16 v[200:201], v245 offset:49152
  ds_read_b64_tr_b16 v[202:203], v245 offset:51200
  v_fma_f32 v84, v84, s32, v249
  v_fma_f32 v85, v85, s32, v249
  v_exp_f32 v84, v84
  v_exp_f32 v85, v85
  v_add_f32 v248, v248, v84
  v_add_f32 v253, v253, v85
  v_cvt_pk_bf16_f32 v82, v84, v85
  v_mfma_f32_32x32x16_bf16 v[176:191], v[204:207], v[64:67], v[176:191]
  ds_read_b64_tr_b16 v[204:205], v246 offset:49152
  ds_read_b64_tr_b16 v[206:207], v246 offset:51200
  v_fma_f32 v86, v86, s32, v249
  v_fma_f32 v87, v87, s32, v249
  v_exp_f32 v86, v86
  v_exp_f32 v87, v87
  v_add_f32 v248, v248, v86
  v_add_f32 v253, v253, v87
  v_cvt_pk_bf16_f32 v83, v86, v87
  v_mfma_f32_32x32x16_bf16 v[128:143], v[208:211], v[68:71], v[128:143]
  ds_read_b64_tr_b16 v[208:209], v243 offset:53248
  ds_read_b64_tr_b16 v[210:211], v243 offset:55296
  v_fma_f32 v88, v88, s32, v249
  v_fma_f32 v89, v89, s32, v249
  v_exp_f32 v88, v88
  v_exp_f32 v89, v89
  v_add_f32 v248, v248, v88
  v_add_f32 v253, v253, v89
  v_cvt_pk_bf16_f32 v84, v88, v89
  v_mfma_f32_32x32x16_bf16 v[144:159], v[212:215], v[68:71], v[144:159]
  ds_read_b64_tr_b16 v[212:213], v244 offset:53248
  ds_read_b64_tr_b16 v[214:215], v244 offset:55296
  v_fma_f32 v90, v90, s32, v249
  v_fma_f32 v91, v91, s32, v249
  v_exp_f32 v90, v90
  v_exp_f32 v91, v91
  v_add_f32 v248, v248, v90
  v_add_f32 v253, v253, v91
  v_cvt_pk_bf16_f32 v85, v90, v91
  v_mfma_f32_32x32x16_bf16 v[160:175], v[216:219], v[68:71], v[160:175]
  ds_read_b64_tr_b16 v[216:217], v245 offset:53248
  ds_read_b64_tr_b16 v[218:219], v245 offset:55296
  v_fma_f32 v92, v92, s32, v249
  v_fma_f32 v93, v93, s32, v249
  v_exp_f32 v92, v92
  v_exp_f32 v93, v93
  v_add_f32 v248, v248, v92
  v_add_f32 v253, v253, v93
  v_cvt_pk_bf16_f32 v86, v92, v93
  v_mfma_f32_32x32x16_bf16 v[176:191], v[220:223], v[68:71], v[176:191]
  ds_read_b64_tr_b16 v[220:221], v246 offset:53248
  ds_read_b64_tr_b16 v[222:223], v246 offset:55296
  v_fma_f32 v94, v94, s32, v249
  v_fma_f32 v95, v95, s32, v249
  v_exp_f32 v94, v94
  v_exp_f32 v95, v95
  v_add_f32 v248, v248, v94
  v_add_f32 v253, v253, v95
  v_cvt_pk_bf16_f32 v87, v94, v95
  s_waitcnt lgkmcnt(0)
  s_waitcnt vmcnt(4)
  s_barrier
  v_add_u32 v243, 0x10000, v243
  v_add_u32 v244, 0x10000, v244
  v_add_u32 v245, 0x10000, v245
  v_add_u32 v246, 0x10000, v246
  s_lshr_b32 s29, s33, 3
  s_lshl_b32 s29, s29, 3
  s_add_u32 s29, s29, s34
  s_mul_i32 s29, s29, 0x28000
  s_and_b32 s30, s33, 7
  s_mul_i32 s30, s30, 0xa0
  v_min_u32 v250, 39, v224
  v_add_u32 v250, s30, v250
  s_mul_i32 s30, s26, 40
  v_add_u32 v250, s30, v250
  v_lshlrev_b32 v250, 7, v250
  buffer_load_dword v225, v250, s[56:59], s29 offen
  v_mfma_f32_32x32x16_bf16 v[128:143], v[192:195], v[80:83], v[128:143]
  ds_read_b64_tr_b16 v[192:193], v243
  ds_read_b64_tr_b16 v[194:195], v243 offset:2048
  v_fma_f32 v96, v96, s32, v249
  v_fma_f32 v97, v97, s32, v249
  v_exp_f32 v96, v96
  v_exp_f32 v97, v97
  v_add_f32 v248, v248, v96
  v_add_f32 v253, v253, v97
  v_cvt_pk_bf16_f32 v96, v96, v97
  v_mfma_f32_32x32x16_bf16 v[144:159], v[196:199], v[80:83], v[144:159]
  ds_read_b64_tr_b16 v[196:197], v244
  ds_read_b64_tr_b16 v[198:199], v244 offset:2048
  v_fma_f32 v98, v98, s32, v249
  v_fma_f32 v99, v99, s32, v249
  v_exp_f32 v98, v98
  v_exp_f32 v99, v99
  v_add_f32 v248, v248, v98
  v_add_f32 v253, v253, v99
  v_cvt_pk_bf16_f32 v97, v98, v99
  v_mfma_f32_32x32x16_bf16 v[160:175], v[200:203], v[80:83], v[160:175]
  ds_read_b64_tr_b16 v[200:201], v245
  ds_read_b64_tr_b16 v[202:203], v245 offset:2048
  v_fma_f32 v100, v100, s32, v249
  v_fma_f32 v101, v101, s32, v249
  v_exp_f32 v100, v100
  v_exp_f32 v101, v101
  v_add_f32 v248, v248, v100
  v_add_f32 v253, v253, v101
  v_cvt_pk_bf16_f32 v98, v100, v101
  v_mfma_f32_32x32x16_bf16 v[176:191], v[204:207], v[80:83], v[176:191]
  ds_read_b64_tr_b16 v[204:205], v246
  ds_read_b64_tr_b16 v[206:207], v246 offset:2048
  v_fma_f32 v102, v102, s32, v249
  v_fma_f32 v103, v103, s32, v249
  v_exp_f32 v102, v102
  v_exp_f32 v103, v103
  v_add_f32 v248, v248, v102
  v_add_f32 v253, v253, v103
  v_cvt_pk_bf16_f32 v99, v102, v103
  v_mfma_f32_32x32x16_bf16 v[128:143], v[208:211], v[84:87], v[128:143]
  ds_read_b64_tr_b16 v[208:209], v243 offset:4096
  ds_read_b64_tr_b16 v[210:211], v243 offset:6144
  v_fma_f32 v104, v104, s32, v249
  v_fma_f32 v105, v105, s32, v249
  v_exp_f32 v104, v104
  v_exp_f32 v105, v105
  v_add_f32 v248, v248, v104
  v_add_f32 v253, v253, v105
  v_cvt_pk_bf16_f32 v100, v104, v105
  v_mfma_f32_32x32x16_bf16 v[144:159], v[212:215], v[84:87], v[144:159]
  ds_read_b64_tr_b16 v[212:213], v244 offset:4096
  ds_read_b64_tr_b16 v[214:215], v244 offset:6144
  v_fma_f32 v106, v106, s32, v249
  v_fma_f32 v107, v107, s32, v249
  v_exp_f32 v106, v106
  v_exp_f32 v107, v107
  v_add_f32 v248, v248, v106
  v_add_f32 v253, v253, v107
  v_cvt_pk_bf16_f32 v101, v106, v107
  v_mfma_f32_32x32x16_bf16 v[160:175], v[216:219], v[84:87], v[160:175]
  ds_read_b64_tr_b16 v[216:217], v245 offset:4096
  ds_read_b64_tr_b16 v[218:219], v245 offset:6144
  v_fma_f32 v108, v108, s32, v249
  v_fma_f32 v109, v109, s32, v249
  v_exp_f32 v108, v108
  v_exp_f32 v109, v109
  v_add_f32 v248, v248, v108
  v_add_f32 v253, v253, v109
  v_cvt_pk_bf16_f32 v102, v108, v109
  v_mfma_f32_32x32x16_bf16 v[176:191], v[220:223], v[84:87], v[176:191]
  ds_read_b64_tr_b16 v[220:221], v246 offset:4096
  ds_read_b64_tr_b16 v[222:223], v246 offset:6144
  v_fma_f32 v110, v110, s32, v249
  v_fma_f32 v111, v111, s32, v249
  v_exp_f32 v110, v110
  v_exp_f32 v111, v111
  v_add_f32 v248, v248, v110
  v_add_f32 v253, v253, v111
  v_cvt_pk_bf16_f32 v103, v110, v111
  s_waitcnt lgkmcnt(0)
  s_waitcnt vmcnt(1)
  s_barrier
  v_mfma_f32_32x32x16_bf16 v[128:143], v[192:195], v[96:99], v[128:143]
  ds_read_b64_tr_b16 v[192:193], v243 offset:16384
  ds_read_b64_tr_b16 v[194:195], v243 offset:18432
  v_fma_f32 v112, v112, s32, v249
  v_fma_f32 v113, v113, s32, v249
  v_exp_f32 v112, v112
  v_exp_f32 v113, v113
  v_add_f32 v248, v248, v112
  v_add_f32 v253, v253, v113
  v_cvt_pk_bf16_f32 v112, v112, v113
  v_fma_f32 v114, v114, s32, v249
  v_mfma_f32_32x32x16_bf16 v[144:159], v[196:199], v[96:99], v[144:159]
  ds_read_b64_tr_b16 v[196:197], v244 offset:16384
  ds_read_b64_tr_b16 v[198:199], v244 offset:18432
  v_fma_f32 v115, v115, s32, v249
  v_exp_f32 v114, v114
  v_exp_f32 v115, v115
  v_add_f32 v248, v248, v114
  v_add_f32 v253, v253, v115
  v_cvt_pk_bf16_f32 v113, v114, v115
  v_fma_f32 v116, v116, s32, v249
  v_fma_f32 v117, v117, s32, v249
  v_mfma_f32_32x32x16_bf16 v[160:175], v[200:203], v[96:99], v[160:175]
  ds_read_b64_tr_b16 v[200:201], v245 offset:16384
  ds_read_b64_tr_b16 v[202:203], v245 offset:18432
  v_exp_f32 v116, v116
  v_exp_f32 v117, v117
  v_add_f32 v248, v248, v116
  v_add_f32 v253, v253, v117
  v_cvt_pk_bf16_f32 v114, v116, v117
  v_fma_f32 v118, v118, s32, v249
  v_fma_f32 v119, v119, s32, v249
  v_exp_f32 v118, v118
  v_mfma_f32_32x32x16_bf16 v[176:191], v[204:207], v[96:99], v[176:191]
  ds_read_b64_tr_b16 v[204:205], v246 offset:16384
  ds_read_b64_tr_b16 v[206:207], v246 offset:18432
  v_exp_f32 v119, v119
  v_add_f32 v248, v248, v118
  v_add_f32 v253, v253, v119
  v_cvt_pk_bf16_f32 v115, v118, v119
  v_fma_f32 v120, v120, s32, v249
  v_fma_f32 v121, v121, s32, v249
  v_exp_f32 v120, v120
  v_exp_f32 v121, v121
  v_mfma_f32_32x32x16_bf16 v[128:143], v[208:211], v[100:103], v[128:143]
  ds_read_b64_tr_b16 v[208:209], v243 offset:20480
  ds_read_b64_tr_b16 v[210:211], v243 offset:22528
  v_add_f32 v248, v248, v120
  v_add_f32 v253, v253, v121
  v_cvt_pk_bf16_f32 v116, v120, v121
  v_fma_f32 v122, v122, s32, v249
  v_fma_f32 v123, v123, s32, v249
  v_exp_f32 v122, v122
  v_exp_f32 v123, v123
  v_add_f32 v248, v248, v122
  v_mfma_f32_32x32x16_bf16 v[144:159], v[212:215], v[100:103], v[144:159]
  ds_read_b64_tr_b16 v[212:213], v244 offset:20480
  ds_read_b64_tr_b16 v[214:215], v244 offset:22528
  v_add_f32 v253, v253, v123
  v_cvt_pk_bf16_f32 v117, v122, v123
  v_fma_f32 v124, v124, s32, v249
  v_fma_f32 v125, v125, s32, v249
  v_exp_f32 v124, v124
  v_exp_f32 v125, v125
  v_add_f32 v248, v248, v124
  v_add_f32 v253, v253, v125
  v_mfma_f32_32x32x16_bf16 v[160:175], v[216:219], v[100:103], v[160:175]
  ds_read_b64_tr_b16 v[216:217], v245 offset:20480
  ds_read_b64_tr_b16 v[218:219], v245 offset:22528
  v_cvt_pk_bf16_f32 v118, v124, v125
  v_fma_f32 v126, v126, s32, v249
  v_fma_f32 v127, v127, s32, v249
  v_exp_f32 v126, v126
  v_exp_f32 v127, v127
  v_add_f32 v248, v248, v126
  v_add_f32 v253, v253, v127
  v_cvt_pk_bf16_f32 v119, v126, v127
  v_mfma_f32_32x32x16_bf16 v[176:191], v[220:223], v[100:103], v[176:191]
  ds_read_b64_tr_b16 v[220:221], v246 offset:20480
  ds_read_b64_tr_b16 v[222:223], v246 offset:22528
  v_add_f32 v248, v248, v253
  v_mov_b32 v250, v248
  s_nop 1
  v_permlane32_swap_b32 v248, v250
  v_add_f32 v248, v248, v250
  s_waitcnt lgkmcnt(0)
  s_barrier
  v_mfma_f32_32x32x16_bf16 v[128:143], v[192:195], v[112:115], v[128:143]
  v_mfma_f32_32x32x16_bf16 v[144:159], v[196:199], v[112:115], v[144:159]
  v_mfma_f32_32x32x16_bf16 v[160:175], v[200:203], v[112:115], v[160:175]
  v_mfma_f32_32x32x16_bf16 v[176:191], v[204:207], v[112:115], v[176:191]
  v_mfma_f32_32x32x16_bf16 v[128:143], v[208:211], v[116:119], v[128:143]
  v_mfma_f32_32x32x16_bf16 v[144:159], v[212:215], v[116:119], v[144:159]
  v_mfma_f32_32x32x16_bf16 v[160:175], v[216:219], v[116:119], v[160:175]
  v_mfma_f32_32x32x16_bf16 v[176:191], v[220:223], v[116:119], v[176:191]
  s_mul_i32 s29, s24, 0x2200
  v_lshlrev_b32 v255, 4, v224
  v_add_u32 v255, s29, v255
  v_lshlrev_b32 v252, 2, v224
  v_add_u32 v252, s29, v252
  ds_write_b32 v252, v247 offset:8192
  ds_write_b32 v252, v248 offset:8448
  s_nop 1
  ds_write_b128 v255, v[128:131]
  ds_write_b128 v255, v[132:135] offset:1024
  ds_write_b128 v255, v[136:139] offset:2048
  ds_write_b128 v255, v[140:143] offset:3072
  ds_write_b128 v255, v[144:147] offset:4096
  ds_write_b128 v255, v[148:151] offset:5120
  ds_write_b128 v255, v[152:155] offset:6144
  ds_write_b128 v255, v[156:159] offset:7168
  s_waitcnt lgkmcnt(0)
  s_barrier
  v_add_u32 v255, 0xffff7800, v255
  v_add_u32 v252, 0xffff7800, v252
  ds_read_b32 v250, v252 offset:8192
  ds_read_b32 v251, v252 offset:8448
  ds_read_b128 v[0:3], v255
  ds_read_b128 v[4:7], v255 offset:1024
  ds_read_b128 v[8:11], v255 offset:2048
  ds_read_b128 v[12:15], v255 offset:3072
  ds_read_b128 v[16:19], v255 offset:4096
  ds_read_b128 v[20:23], v255 offset:5120
  ds_read_b128 v[24:27], v255 offset:6144
  ds_read_b128 v[28:31], v255 offset:7168
  s_waitcnt lgkmcnt(9)
  v_max_f32 v253, v247, v250
  v_sub_f32 v247, v247, v253
  v_sub_f32 v250, v250, v253
  v_mul_f32 v247, s32, v247
  v_mul_f32 v250, s32, v250
  v_exp_f32 v247, v247
  v_exp_f32 v250, v250
  v_mul_f32 v248, v248, v247
  s_waitcnt lgkmcnt(8)
  v_fma_f32 v248, v251, v250, v248
  v_rcp_f32 v248, v248
  s_nop 0
  v_mul_f32 v247, v247, v248
  v_mul_f32 v250, v250, v248
  s_waitcnt lgkmcnt(7)
  v_mul_f32 v0, v0, v250
  v_fma_f32 v0, v160, v247, v0
  v_mul_f32 v1, v1, v250
  v_fma_f32 v1, v161, v247, v1
  v_mul_f32 v2, v2, v250
  v_fma_f32 v2, v162, v247, v2
  v_mul_f32 v3, v3, v250
  v_fma_f32 v3, v163, v247, v3
  s_waitcnt lgkmcnt(6)
  v_mul_f32 v4, v4, v250
  v_fma_f32 v4, v164, v247, v4
  v_mul_f32 v5, v5, v250
  v_fma_f32 v5, v165, v247, v5
  v_mul_f32 v6, v6, v250
  v_fma_f32 v6, v166, v247, v6
  v_mul_f32 v7, v7, v250
  v_fma_f32 v7, v167, v247, v7
  s_waitcnt lgkmcnt(5)
  v_mul_f32 v8, v8, v250
  v_fma_f32 v8, v168, v247, v8
  v_mul_f32 v9, v9, v250
  v_fma_f32 v9, v169, v247, v9
  v_mul_f32 v10, v10, v250
  v_fma_f32 v10, v170, v247, v10
  v_mul_f32 v11, v11, v250
  v_fma_f32 v11, v171, v247, v11
  s_waitcnt lgkmcnt(4)
  v_mul_f32 v12, v12, v250
  v_fma_f32 v12, v172, v247, v12
  v_mul_f32 v13, v13, v250
  v_fma_f32 v13, v173, v247, v13
  v_mul_f32 v14, v14, v250
  v_fma_f32 v14, v174, v247, v14
  v_mul_f32 v15, v15, v250
  v_fma_f32 v15, v175, v247, v15
  s_waitcnt lgkmcnt(3)
  v_mul_f32 v16, v16, v250
  v_fma_f32 v16, v176, v247, v16
  v_mul_f32 v17, v17, v250
  v_fma_f32 v17, v177, v247, v17
  v_mul_f32 v18, v18, v250
  v_fma_f32 v18, v178, v247, v18
  v_mul_f32 v19, v19, v250
  v_fma_f32 v19, v179, v247, v19
  s_waitcnt lgkmcnt(2)
  v_mul_f32 v20, v20, v250
  v_fma_f32 v20, v180, v247, v20
  v_mul_f32 v21, v21, v250
  v_fma_f32 v21, v181, v247, v21
  v_mul_f32 v22, v22, v250
  v_fma_f32 v22, v182, v247, v22
  v_mul_f32 v23, v23, v250
  v_fma_f32 v23, v183, v247, v23
  s_waitcnt lgkmcnt(1)
  v_mul_f32 v24, v24, v250
  v_fma_f32 v24, v184, v247, v24
  v_mul_f32 v25, v25, v250
  v_fma_f32 v25, v185, v247, v25
  v_mul_f32 v26, v26, v250
  v_fma_f32 v26, v186, v247, v26
  v_mul_f32 v27, v27, v250
  v_fma_f32 v27, v187, v247, v27
  s_waitcnt lgkmcnt(0)
  v_mul_f32 v28, v28, v250
  v_fma_f32 v28, v188, v247, v28
  v_mul_f32 v29, v29, v250
  v_fma_f32 v29, v189, v247, v29
  v_mul_f32 v30, v30, v250
  v_fma_f32 v30, v190, v247, v30
  v_mul_f32 v31, v31, v250
  v_fma_f32 v31, v191, v247, v31
  v_cvt_pk_bf16_f32 v32, v0, v1
  v_cvt_pk_bf16_f32 v33, v2, v3
  v_cvt_pk_bf16_f32 v34, v4, v5
  v_cvt_pk_bf16_f32 v35, v6, v7
  v_cvt_pk_bf16_f32 v36, v8, v9
  v_cvt_pk_bf16_f32 v37, v10, v11
  v_cvt_pk_bf16_f32 v38, v12, v13
  v_cvt_pk_bf16_f32 v39, v14, v15
  v_cvt_pk_bf16_f32 v40, v16, v17
  v_cvt_pk_bf16_f32 v41, v18, v19
  v_cvt_pk_bf16_f32 v42, v20, v21
  v_cvt_pk_bf16_f32 v43, v22, v23
  v_cvt_pk_bf16_f32 v44, v24, v25
  v_cvt_pk_bf16_f32 v45, v26, v27
  v_cvt_pk_bf16_f32 v46, v28, v29
  v_cvt_pk_bf16_f32 v47, v30, v31
  s_lshl_b32 s29, s2, 2
  s_add_u32 s29, s29, s26
  s_lshl_b32 s29, s29, 13
  s_add_u32 s29, s29, 0x1000
  v_lshlrev_b32 v254, 4, v224
  v_add_u32 v254, s29, v254
  buffer_store_dwordx4 v[32:35], v254, s[20:23], 0 offen
  buffer_store_dwordx4 v[36:39], v254, s[20:23], 0 offen offset:1024
  buffer_store_dwordx4 v[40:43], v254, s[20:23], 0 offen offset:2048
  buffer_store_dwordx4 v[44:47], v254, s[20:23], 0 offen offset:3072
  s_endpgm
.LEND_F:
  s_endpgm
.globl oproj_kernel
.p2align 8
.type oproj_kernel,@function
oproj_kernel:
  s_load_dwordx2 s[46:47], s[0:1], 32
  s_load_dwordx2 s[54:55], s[0:1], 56
  s_cmp_ge_u32 s2, 0x100
  s_cbranch_scc1 .LEND_K2
  v_and_b32 v224, 63, v0
  v_lshrrev_b32 v250, 6, v0
  s_nop 0
  v_readfirstlane_b32 s24, v250
  s_nop 3
  s_lshr_b32 s25, s24, 2
  s_and_b32 s26, s24, 3
  s_lshr_b32 s27, s2, 5
  s_and_b32 s28, s2, 31
  s_and_b32 s34, s2, 7
  s_lshr_b32 s35, s28, 3
  s_waitcnt lgkmcnt(0)
  s_mov_b32 s44, s54
  s_mov_b32 s45, s55
  s_mov_b32 s20, s54
  s_and_b32 s21, s55, 0xffff
  s_mov_b32 s22, 0x800000
  s_mov_b32 s23, 0x20000
  s_mov_b32 s56, s46
  s_and_b32 s57, s47, 0xffff
  s_mov_b32 s58, 0x500000
  s_mov_b32 s59, 0x20000
  s_mov_b32 s29, 0x800000
  s_add_u32 s60, s54, s29
  s_addc_u32 s61, s55, 0
  s_and_b32 s61, s61, 0xffff
  s_mov_b32 s62, 0xa00000
  s_mov_b32 s63, 0x20000
  s_cmp_lg_u32 s25, 0
  s_cbranch_scc1 .LK2ROLE1
  v_lshlrev_b32 v253, 4, v224
  s_lshl_b32 s29, s27, 5
  s_add_u32 s29, s29, s34
  s_add_u32 s29, s29, 0
  s_lshl_b32 s29, s29, 2
  s_add_u32 s29, s29, s26
  s_lshl_b32 s29, s29, 13
  buffer_load_dwordx4 v[0:3], v253, s[20:23], s29 offen
  buffer_load_dwordx4 v[4:7], v253, s[20:23], s29 offen offset:1024
  buffer_load_dwordx4 v[8:11], v253, s[20:23], s29 offen offset:2048
  buffer_load_dwordx4 v[12:15], v253, s[20:23], s29 offen offset:3072
  s_add_u32 s29, s29, 0x1000
  buffer_load_dwordx4 v[16:19], v253, s[20:23], s29 offen
  buffer_load_dwordx4 v[20:23], v253, s[20:23], s29 offen offset:1024
  buffer_load_dwordx4 v[24:27], v253, s[20:23], s29 offen offset:2048
  buffer_load_dwordx4 v[28:31], v253, s[20:23], s29 offen offset:3072
  s_lshl_b32 s29, s27, 5
  s_add_u32 s29, s29, s34
  s_add_u32 s29, s29, 8
  s_lshl_b32 s29, s29, 2
  s_add_u32 s29, s29, s26
  s_lshl_b32 s29, s29, 13
  buffer_load_dwordx4 v[32:35], v253, s[20:23], s29 offen
  buffer_load_dwordx4 v[36:39], v253, s[20:23], s29 offen offset:1024
  buffer_load_dwordx4 v[40:43], v253, s[20:23], s29 offen offset:2048
  buffer_load_dwordx4 v[44:47], v253, s[20:23], s29 offen offset:3072
  s_add_u32 s29, s29, 0x1000
  buffer_load_dwordx4 v[48:51], v253, s[20:23], s29 offen
  buffer_load_dwordx4 v[52:55], v253, s[20:23], s29 offen offset:1024
  buffer_load_dwordx4 v[56:59], v253, s[20:23], s29 offen offset:2048
  buffer_load_dwordx4 v[60:63], v253, s[20:23], s29 offen offset:3072
  v_lshlrev_b32 v250, 4, v224
  v_add_u32 v250, 0, v250
  v_mul_u32_u24 v251, 0xccd, v250
  v_lshrrev_b32 v251, 20, v251
  v_mul_u32_u24 v252, 0x140, v251
  v_sub_u32 v252, v250, v252
  v_mul_u32_u24 v251, 0x500, v251
  v_add_u32 v251, v251, v252
  s_mul_i32 s29, s35, 0x140
  s_add_u32 s29, s29, 0
  v_add_u32 v204, s29, v251
  v_lshlrev_b32 v250, 4, v224
  v_add_u32 v250, 0x400, v250
  v_mul_u32_u24 v251, 0xccd, v250
  v_lshrrev_b32 v251, 20, v251
  v_mul_u32_u24 v252, 0x140, v251
  v_sub_u32 v252, v250, v252
  v_mul_u32_u24 v251, 0x500, v251
  v_add_u32 v251, v251, v252
  s_mul_i32 s29, s35, 0x140
  s_add_u32 s29, s29, 0xfffffc00
  v_add_u32 v205, s29, v251
  v_lshlrev_b32 v250, 4, v224
  v_add_u32 v250, 0x800, v250
  v_mul_u32_u24 v251, 0xccd, v250
  v_lshrrev_b32 v251, 20, v251
  v_mul_u32_u24 v252, 0x140, v251
  v_sub_u32 v252, v250, v252
  v_mul_u32_u24 v251, 0x500, v251
  v_add_u32 v251, v251, v252
  s_mul_i32 s29, s35, 0x140
  s_add_u32 s29, s29, 0xfffff800
  v_add_u32 v206, s29, v251
  v_lshlrev_b32 v250, 4, v224
  v_add_u32 v250, 0xc00, v250
  v_mul_u32_u24 v251, 0xccd, v250
  v_lshrrev_b32 v251, 20, v251
  v_mul_u32_u24 v252, 0x140, v251
  v_sub_u32 v252, v250, v252
  v_mul_u32_u24 v251, 0x500, v251
  v_add_u32 v251, v251, v252
  s_mul_i32 s29, s35, 0x140
  s_add_u32 s29, s29, 0xfffff400
  v_add_u32 v207, s29, v251
  v_lshlrev_b32 v250, 4, v224
  v_add_u32 v250, 0x1000, v250
  v_mul_u32_u24 v251, 0xccd, v250
  v_lshrrev_b32 v251, 20, v251
  v_mul_u32_u24 v252, 0x140, v251
  v_sub_u32 v252, v250, v252
  v_mul_u32_u24 v251, 0x500, v251
  v_add_u32 v251, v251, v252
  s_mul_i32 s29, s35, 0x140
  s_add_u32 s29, s29, 0
  v_add_u32 v208, s29, v251
  s_lshl_b32 s29, s25, 1
  s_add_u32 s29, s29, 0
  s_lshl_b32 s30, s29, 7
  s_lshl_b32 s33, s26, 5
  s_add_u32 s30, s30, s33
  s_mul_i32 s30, s30, 0x140
  s_lshl_b32 s29, s29, 3
  s_add_u32 s29, s29, s34
  s_lshl_b32 s29, s29, 7
  s_add_u32 s29, s29, s33
  s_mul_i32 s29, s29, 0x500
  s_add_u32 m0, s30, 0
  s_nop 0
  buffer_load_dwordx4 v204, s[56:59], s29 offen lds
  buffer_load_dwordx4 v205, s[56:59], s29 offen offset:1024 lds
  buffer_load_dwordx4 v206, s[56:59], s29 offen offset:2048 lds
  buffer_load_dwordx4 v207, s[56:59], s29 offen offset:3072 lds
  s_add_u32 m0, s30, 0x1000
  s_nop 0
  buffer_load_dwordx4 v208, s[56:59], s29 offen lds
  s_add_u32 s29, s29, 0x5000
  s_add_u32 m0, s30, 0x1400
  s_nop 0
  buffer_load_dwordx4 v204, s[56:59], s29 offen lds
  buffer_load_dwordx4 v205, s[56:59], s29 offen offset:1024 lds
  buffer_load_dwordx4 v206, s[56:59], s29 offen offset:2048 lds
  buffer_load_dwordx4 v207, s[56:59], s29 offen offset:3072 lds
  s_add_u32 m0, s30, 0x2400
  s_nop 0
  buffer_load_dwordx4 v208, s[56:59], s29 offen lds
  s_lshl_b32 s29, s25, 1
  s_add_u32 s29, s29, 1
  s_lshl_b32 s30, s29, 7
  s_lshl_b32 s33, s26, 5
  s_add_u32 s30, s30, s33
  s_mul_i32 s30, s30, 0x140
  s_lshl_b32 s29, s29, 3
  s_add_u32 s29, s29, s34
  s_lshl_b32 s29, s29, 7
  s_add_u32 s29, s29, s33
  s_mul_i32 s29, s29, 0x500
  s_add_u32 m0, s30, 0
  s_nop 0
  buffer_load_dwordx4 v204, s[56:59], s29 offen lds
  buffer_load_dwordx4 v205, s[56:59], s29 offen offset:1024 lds
  buffer_load_dwordx4 v206, s[56:59], s29 offen offset:2048 lds
  buffer_load_dwordx4 v207, s[56:59], s29 offen offset:3072 lds
  s_add_u32 m0, s30, 0x1000
  s_nop 0
  buffer_load_dwordx4 v208, s[56:59], s29 offen lds
  s_add_u32 s29, s29, 0x5000
  s_add_u32 m0, s30, 0x1400
  s_nop 0
  buffer_load_dwordx4 v204, s[56:59], s29 offen lds
  buffer_load_dwordx4 v205, s[56:59], s29 offen offset:1024 lds
  buffer_load_dwordx4 v206, s[56:59], s29 offen offset:2048 lds
  buffer_load_dwordx4 v207, s[56:59], s29 offen offset:3072 lds
  s_add_u32 m0, s30, 0x2400
  s_nop 0
  buffer_load_dwordx4 v208, s[56:59], s29 offen lds
  v_lshrrev_b32 v251, 5, v224
  v_lshrrev_b32 v250, 2, v224
  v_and_b32 v250, 3, v250
  v_lshl_add_u32 v250, v251, 3, v250
  v_add_u32 v250, 0, v250
  v_mul_u32_u24 v250, 0x140, v250
  v_and_b32 v251, 1, v224
  v_lshl_add_u32 v250, v251, 4, v250
  v_and_b32 v251, 2, v224
  v_lshl_add_u32 v250, v251, 2, v250
  v_and_b32 v251, 16, v224
  v_lshl_add_u32 v227, v251, 1, v250
  s_waitcnt vmcnt(10)
  s_barrier
  ds_read_b64_tr_b16 v[144:145], v227
  ds_read_b64_tr_b16 v[146:147], v227 offset:1280
  ds_read_b64_tr_b16 v[148:149], v227 offset:64
  ds_read_b64_tr_b16 v[150:151], v227 offset:1344
  ds_read_b64_tr_b16 v[152:153], v227 offset:128
  ds_read_b64_tr_b16 v[154:155], v227 offset:1408
  ds_read_b64_tr_b16 v[156:157], v227 offset:192
  ds_read_b64_tr_b16 v[158:159], v227 offset:1472
  ds_read_b64_tr_b16 v[160:161], v227 offset:256
  ds_read_b64_tr_b16 v[162:163], v227 offset:1536
  ds_read_b64_tr_b16 v[164:165], v227 offset:5120
  ds_read_b64_tr_b16 v[166:167], v227 offset:6400
  ds_read_b64_tr_b16 v[168:169], v227 offset:5184
  ds_read_b64_tr_b16 v[170:171], v227 offset:6464
  ds_read_b64_tr_b16 v[172:173], v227 offset:5248
  ds_read_b64_tr_b16 v[174:175], v227 offset:6528
  ds_read_b64_tr_b16 v[176:177], v227 offset:5312
  ds_read_b64_tr_b16 v[178:179], v227 offset:6592
  ds_read_b64_tr_b16 v[180:181], v227 offset:5376
  ds_read_b64_tr_b16 v[182:183], v227 offset:6656
  ds_read_b64_tr_b16 v[184:185], v227 offset:10240
  ds_read_b64_tr_b16 v[186:187], v227 offset:11520
  ds_read_b64_tr_b16 v[188:189], v227 offset:10304
  ds_read_b64_tr_b16 v[190:191], v227 offset:11584
  ds_read_b64_tr_b16 v[192:193], v227 offset:10368
  ds_read_b64_tr_b16 v[194:195], v227 offset:11648
  ds_read_b64_tr_b16 v[196:197], v227 offset:10432
  ds_read_b64_tr_b16 v[198:199], v227 offset:11712
  ds_read_b64_tr_b16 v[200:201], v227 offset:10496
  ds_read_b64_tr_b16 v[202:203], v227 offset:11776
  s_waitcnt lgkmcnt(15)
  v_mfma_f32_32x32x16_bf16 v[64:79], v[144:147], v[0:3], 0
  v_mfma_f32_32x32x16_bf16 v[80:95], v[148:151], v[0:3], 0
  v_mfma_f32_32x32x16_bf16 v[96:111], v[152:155], v[0:3], 0
  v_mfma_f32_32x32x16_bf16 v[112:127], v[156:159], v[0:3], 0
  v_mfma_f32_32x32x16_bf16 v[128:143], v[160:163], v[0:3], 0
  ds_read_b64_tr_b16 v[144:145], v227 offset:15360
  ds_read_b64_tr_b16 v[146:147], v227 offset:16640
  ds_read_b64_tr_b16 v[148:149], v227 offset:15424
  ds_read_b64_tr_b16 v[150:151], v227 offset:16704
  ds_read_b64_tr_b16 v[152:153], v227 offset:15488
  ds_read_b64_tr_b16 v[154:155], v227 offset:16768
  ds_read_b64_tr_b16 v[156:157], v227 offset:15552
  ds_read_b64_tr_b16 v[158:159], v227 offset:16832
  ds_read_b64_tr_b16 v[160:161], v227 offset:15616
  ds_read_b64_tr_b16 v[162:163], v227 offset:16896
  v_mfma_f32_32x32x16_bf16 v[64:79], v[164:167], v[4:7], v[64:79]
  v_mfma_f32_32x32x16_bf16 v[80:95], v[168:171], v[4:7], v[80:95]
  s_waitcnt lgkmcnt(15)
  v_mfma_f32_32x32x16_bf16 v[96:111], v[172:175], v[4:7], v[96:111]
  v_mfma_f32_32x32x16_bf16 v[112:127], v[176:179], v[4:7], v[112:127]
  v_mfma_f32_32x32x16_bf16 v[128:143], v[180:183], v[4:7], v[128:143]
  ds_read_b64_tr_b16 v[164:165], v227 offset:20480
  ds_read_b64_tr_b16 v[166:167], v227 offset:21760
  ds_read_b64_tr_b16 v[168:169], v227 offset:20544
  ds_read_b64_tr_b16 v[170:171], v227 offset:21824
  ds_read_b64_tr_b16 v[172:173], v227 offset:20608
  ds_read_b64_tr_b16 v[174:175], v227 offset:21888
  ds_read_b64_tr_b16 v[176:177], v227 offset:20672
  ds_read_b64_tr_b16 v[178:179], v227 offset:21952
  ds_read_b64_tr_b16 v[180:181], v227 offset:20736
  ds_read_b64_tr_b16 v[182:183], v227 offset:22016
  v_mfma_f32_32x32x16_bf16 v[64:79], v[184:187], v[8:11], v[64:79]
  v_mfma_f32_32x32x16_bf16 v[80:95], v[188:191], v[8:11], v[80:95]
  s_waitcnt lgkmcnt(15)
  v_mfma_f32_32x32x16_bf16 v[96:111], v[192:195], v[8:11], v[96:111]
  v_mfma_f32_32x32x16_bf16 v[112:127], v[196:199], v[8:11], v[112:127]
  v_mfma_f32_32x32x16_bf16 v[128:143], v[200:203], v[8:11], v[128:143]
  ds_read_b64_tr_b16 v[184:185], v227 offset:25600
  ds_read_b64_tr_b16 v[186:187], v227 offset:26880
  ds_read_b64_tr_b16 v[188:189], v227 offset:25664
  ds_read_b64_tr_b16 v[190:191], v227 offset:26944
  ds_read_b64_tr_b16 v[192:193], v227 offset:25728
  ds_read_b64_tr_b16 v[194:195], v227 offset:27008
  ds_read_b64_tr_b16 v[196:197], v227 offset:25792
  ds_read_b64_tr_b16 v[198:199], v227 offset:27072
  ds_read_b64_tr_b16 v[200:201], v227 offset:25856
  ds_read_b64_tr_b16 v[202:203], v227 offset:27136
  v_mfma_f32_32x32x16_bf16 v[64:79], v[144:147], v[12:15], v[64:79]
  v_mfma_f32_32x32x16_bf16 v[80:95], v[148:151], v[12:15], v[80:95]
  s_waitcnt lgkmcnt(15)
  v_mfma_f32_32x32x16_bf16 v[96:111], v[152:155], v[12:15], v[96:111]
  v_mfma_f32_32x32x16_bf16 v[112:127], v[156:159], v[12:15], v[112:127]
  v_mfma_f32_32x32x16_bf16 v[128:143], v[160:163], v[12:15], v[128:143]
  ds_read_b64_tr_b16 v[144:145], v227 offset:30720
  ds_read_b64_tr_b16 v[146:147], v227 offset:32000
  ds_read_b64_tr_b16 v[148:149], v227 offset:30784
  ds_read_b64_tr_b16 v[150:151], v227 offset:32064
  ds_read_b64_tr_b16 v[152:153], v227 offset:30848
  ds_read_b64_tr_b16 v[154:155], v227 offset:32128
  ds_read_b64_tr_b16 v[156:157], v227 offset:30912
  ds_read_b64_tr_b16 v[158:159], v227 offset:32192
  ds_read_b64_tr_b16 v[160:161], v227 offset:30976
  ds_read_b64_tr_b16 v[162:163], v227 offset:32256
  v_mfma_f32_32x32x16_bf16 v[64:79], v[164:167], v[16:19], v[64:79]
  v_mfma_f32_32x32x16_bf16 v[80:95], v[168:171], v[16:19], v[80:95]
  s_waitcnt lgkmcnt(15)
  v_mfma_f32_32x32x16_bf16 v[96:111], v[172:175], v[16:19], v[96:111]
  v_mfma_f32_32x32x16_bf16 v[112:127], v[176:179], v[16:19], v[112:127]
  v_mfma_f32_32x32x16_bf16 v[128:143], v[180:183], v[16:19], v[128:143]
  ds_read_b64_tr_b16 v[164:165], v227 offset:35840
  ds_read_b64_tr_b16 v[166:167], v227 offset:37120
  ds_read_b64_tr_b16 v[168:169], v227 offset:35904
  ds_read_b64_tr_b16 v[170:171], v227 offset:37184
  ds_read_b64_tr_b16 v[172:173], v227 offset:35968
  ds_read_b64_tr_b16 v[174:175], v227 offset:37248
  ds_read_b64_tr_b16 v[176:177], v227 offset:36032
  ds_read_b64_tr_b16 v[178:179], v227 offset:37312
  ds_read_b64_tr_b16 v[180:181], v227 offset:36096
  ds_read_b64_tr_b16 v[182:183], v227 offset:37376
  v_mfma_f32_32x32x16_bf16 v[64:79], v[184:187], v[20:23], v[64:79]
  v_mfma_f32_32x32x16_bf16 v[80:95], v[188:191], v[20:23], v[80:95]
  s_waitcnt lgkmcnt(15)
  v_mfma_f32_32x32x16_bf16 v[96:111], v[192:195], v[20:23], v[96:111]
  v_mfma_f32_32x32x16_bf16 v[112:127], v[196:199], v[20:23], v[112:127]
  v_mfma_f32_32x32x16_bf16 v[128:143], v[200:203], v[20:23], v[128:143]
  s_waitcnt vmcnt(0)
  s_barrier
  v_add_u32 v227, 0xa000, v227
  ds_read_b64_tr_b16 v[184:185], v227
  ds_read_b64_tr_b16 v[186:187], v227 offset:1280
  ds_read_b64_tr_b16 v[188:189], v227 offset:64
  ds_read_b64_tr_b16 v[190:191], v227 offset:1344
  ds_read_b64_tr_b16 v[192:193], v227 offset:128
  ds_read_b64_tr_b16 v[194:195], v227 offset:1408
  ds_read_b64_tr_b16 v[196:197], v227 offset:192
  ds_read_b64_tr_b16 v[198:199], v227 offset:1472
  ds_read_b64_tr_b16 v[200:201], v227 offset:256
  ds_read_b64_tr_b16 v[202:203], v227 offset:1536
  v_mfma_f32_32x32x16_bf16 v[64:79], v[144:147], v[24:27], v[64:79]
  v_mfma_f32_32x32x16_bf16 v[80:95], v[148:151], v[24:27], v[80:95]
  s_waitcnt lgkmcnt(15)
  v_mfma_f32_32x32x16_bf16 v[96:111], v[152:155], v[24:27], v[96:111]
  v_mfma_f32_32x32x16_bf16 v[112:127], v[156:159], v[24:27], v[112:127]
  v_mfma_f32_32x32x16_bf16 v[128:143], v[160:163], v[24:27], v[128:143]
  ds_read_b64_tr_b16 v[144:145], v227 offset:5120
  ds_read_b64_tr_b16 v[146:147], v227 offset:6400
  ds_read_b64_tr_b16 v[148:149], v227 offset:5184
  ds_read_b64_tr_b16 v[150:151], v227 offset:6464
  ds_read_b64_tr_b16 v[152:153], v227 offset:5248
  ds_read_b64_tr_b16 v[154:155], v227 offset:6528
  ds_read_b64_tr_b16 v[156:157], v227 offset:5312
  ds_read_b64_tr_b16 v[158:159], v227 offset:6592
  ds_read_b64_tr_b16 v[160:161], v227 offset:5376
  ds_read_b64_tr_b16 v[162:163], v227 offset:6656
  v_mfma_f32_32x32x16_bf16 v[64:79], v[164:167], v[28:31], v[64:79]
  v_mfma_f32_32x32x16_bf16 v[80:95], v[168:171], v[28:31], v[80:95]
  s_waitcnt lgkmcnt(15)
  v_mfma_f32_32x32x16_bf16 v[96:111], v[172:175], v[28:31], v[96:111]
  v_mfma_f32_32x32x16_bf16 v[112:127], v[176:179], v[28:31], v[112:127]
  v_mfma_f32_32x32x16_bf16 v[128:143], v[180:183], v[28:31], v[128:143]
  ds_read_b64_tr_b16 v[164:165], v227 offset:10240
  ds_read_b64_tr_b16 v[166:167], v227 offset:11520
  ds_read_b64_tr_b16 v[168:169], v227 offset:10304
  ds_read_b64_tr_b16 v[170:171], v227 offset:11584
  ds_read_b64_tr_b16 v[172:173], v227 offset:10368
  ds_read_b64_tr_b16 v[174:175], v227 offset:11648
  ds_read_b64_tr_b16 v[176:177], v227 offset:10432
  ds_read_b64_tr_b16 v[178:179], v227 offset:11712
  ds_read_b64_tr_b16 v[180:181], v227 offset:10496
  ds_read_b64_tr_b16 v[182:183], v227 offset:11776
  v_mfma_f32_32x32x16_bf16 v[64:79], v[184:187], v[32:35], v[64:79]
  v_mfma_f32_32x32x16_bf16 v[80:95], v[188:191], v[32:35], v[80:95]
  s_waitcnt lgkmcnt(15)
  v_mfma_f32_32x32x16_bf16 v[96:111], v[192:195], v[32:35], v[96:111]
  v_mfma_f32_32x32x16_bf16 v[112:127], v[196:199], v[32:35], v[112:127]
  v_mfma_f32_32x32x16_bf16 v[128:143], v[200:203], v[32:35], v[128:143]
  ds_read_b64_tr_b16 v[184:185], v227 offset:15360
  ds_read_b64_tr_b16 v[186:187], v227 offset:16640
  ds_read_b64_tr_b16 v[188:189], v227 offset:15424
  ds_read_b64_tr_b16 v[190:191], v227 offset:16704
  ds_read_b64_tr_b16 v[192:193], v227 offset:15488
  ds_read_b64_tr_b16 v[194:195], v227 offset:16768
  ds_read_b64_tr_b16 v[196:197], v227 offset:15552
  ds_read_b64_tr_b16 v[198:199], v227 offset:16832
  ds_read_b64_tr_b16 v[200:201], v227 offset:15616
  ds_read_b64_tr_b16 v[202:203], v227 offset:16896
  v_mfma_f32_32x32x16_bf16 v[64:79], v[144:147], v[36:39], v[64:79]
  v_mfma_f32_32x32x16_bf16 v[80:95], v[148:151], v[36:39], v[80:95]
  s_waitcnt lgkmcnt(15)
  v_mfma_f32_32x32x16_bf16 v[96:111], v[152:155], v[36:39], v[96:111]
  v_mfma_f32_32x32x16_bf16 v[112:127], v[156:159], v[36:39], v[112:127]
  v_mfma_f32_32x32x16_bf16 v[128:143], v[160:163], v[36:39], v[128:143]
  ds_read_b64_tr_b16 v[144:145], v227 offset:20480
  ds_read_b64_tr_b16 v[146:147], v227 offset:21760
  ds_read_b64_tr_b16 v[148:149], v227 offset:20544
  ds_read_b64_tr_b16 v[150:151], v227 offset:21824
  ds_read_b64_tr_b16 v[152:153], v227 offset:20608
  ds_read_b64_tr_b16 v[154:155], v227 offset:21888
  ds_read_b64_tr_b16 v[156:157], v227 offset:20672
  ds_read_b64_tr_b16 v[158:159], v227 offset:21952
  ds_read_b64_tr_b16 v[160:161], v227 offset:20736
  ds_read_b64_tr_b16 v[162:163], v227 offset:22016
  v_mfma_f32_32x32x16_bf16 v[64:79], v[164:167], v[40:43], v[64:79]
  v_mfma_f32_32x32x16_bf16 v[80:95], v[168:171], v[40:43], v[80:95]
  s_waitcnt lgkmcnt(15)
  v_mfma_f32_32x32x16_bf16 v[96:111], v[172:175], v[40:43], v[96:111]
  v_mfma_f32_32x32x16_bf16 v[112:127], v[176:179], v[40:43], v[112:127]
  v_mfma_f32_32x32x16_bf16 v[128:143], v[180:183], v[40:43], v[128:143]
  ds_read_b64_tr_b16 v[164:165], v227 offset:25600
  ds_read_b64_tr_b16 v[166:167], v227 offset:26880
  ds_read_b64_tr_b16 v[168:169], v227 offset:25664
  ds_read_b64_tr_b16 v[170:171], v227 offset:26944
  ds_read_b64_tr_b16 v[172:173], v227 offset:25728
  ds_read_b64_tr_b16 v[174:175], v227 offset:27008
  ds_read_b64_tr_b16 v[176:177], v227 offset:25792
  ds_read_b64_tr_b16 v[178:179], v227 offset:27072
  ds_read_b64_tr_b16 v[180:181], v227 offset:25856
  ds_read_b64_tr_b16 v[182:183], v227 offset:27136
  v_mfma_f32_32x32x16_bf16 v[64:79], v[184:187], v[44:47], v[64:79]
  v_mfma_f32_32x32x16_bf16 v[80:95], v[188:191], v[44:47], v[80:95]
  s_waitcnt lgkmcnt(15)
  v_mfma_f32_32x32x16_bf16 v[96:111], v[192:195], v[44:47], v[96:111]
  v_mfma_f32_32x32x16_bf16 v[112:127], v[196:199], v[44:47], v[112:127]
  v_mfma_f32_32x32x16_bf16 v[128:143], v[200:203], v[44:47], v[128:143]
  ds_read_b64_tr_b16 v[184:185], v227 offset:30720
  ds_read_b64_tr_b16 v[186:187], v227 offset:32000
  ds_read_b64_tr_b16 v[188:189], v227 offset:30784
  ds_read_b64_tr_b16 v[190:191], v227 offset:32064
  ds_read_b64_tr_b16 v[192:193], v227 offset:30848
  ds_read_b64_tr_b16 v[194:195], v227 offset:32128
  ds_read_b64_tr_b16 v[196:197], v227 offset:30912
  ds_read_b64_tr_b16 v[198:199], v227 offset:32192
  ds_read_b64_tr_b16 v[200:201], v227 offset:30976
  ds_read_b64_tr_b16 v[202:203], v227 offset:32256
  v_mfma_f32_32x32x16_bf16 v[64:79], v[144:147], v[48:51], v[64:79]
  v_mfma_f32_32x32x16_bf16 v[80:95], v[148:151], v[48:51], v[80:95]
  s_waitcnt lgkmcnt(15)
  v_mfma_f32_32x32x16_bf16 v[96:111], v[152:155], v[48:51], v[96:111]
  v_mfma_f32_32x32x16_bf16 v[112:127], v[156:159], v[48:51], v[112:127]
  v_mfma_f32_32x32x16_bf16 v[128:143], v[160:163], v[48:51], v[128:143]
  ds_read_b64_tr_b16 v[144:145], v227 offset:35840
  ds_read_b64_tr_b16 v[146:147], v227 offset:37120
  ds_read_b64_tr_b16 v[148:149], v227 offset:35904
  ds_read_b64_tr_b16 v[150:151], v227 offset:37184
  ds_read_b64_tr_b16 v[152:153], v227 offset:35968
  ds_read_b64_tr_b16 v[154:155], v227 offset:37248
  ds_read_b64_tr_b16 v[156:157], v227 offset:36032
  ds_read_b64_tr_b16 v[158:159], v227 offset:37312
  ds_read_b64_tr_b16 v[160:161], v227 offset:36096
  ds_read_b64_tr_b16 v[162:163], v227 offset:37376
  v_mfma_f32_32x32x16_bf16 v[64:79], v[164:167], v[52:55], v[64:79]
  v_mfma_f32_32x32x16_bf16 v[80:95], v[168:171], v[52:55], v[80:95]
  s_waitcnt lgkmcnt(15)
  v_mfma_f32_32x32x16_bf16 v[96:111], v[172:175], v[52:55], v[96:111]
  v_mfma_f32_32x32x16_bf16 v[112:127], v[176:179], v[52:55], v[112:127]
  v_mfma_f32_32x32x16_bf16 v[128:143], v[180:183], v[52:55], v[128:143]
  v_mfma_f32_32x32x16_bf16 v[64:79], v[184:187], v[56:59], v[64:79]
  v_mfma_f32_32x32x16_bf16 v[80:95], v[188:191], v[56:59], v[80:95]
  s_waitcnt lgkmcnt(14)
  v_mfma_f32_32x32x16_bf16 v[96:111], v[192:195], v[56:59], v[96:111]
  s_waitcnt lgkmcnt(12)
  v_mfma_f32_32x32x16_bf16 v[112:127], v[196:199], v[56:59], v[112:127]
  s_waitcnt lgkmcnt(10)
  v_mfma_f32_32x32x16_bf16 v[128:143], v[200:203], v[56:59], v[128:143]
  s_waitcnt lgkmcnt(8)
  v_mfma_f32_32x32x16_bf16 v[64:79], v[144:147], v[60:63], v[64:79]
  s_waitcnt lgkmcnt(6)
  v_mfma_f32_32x32x16_bf16 v[80:95], v[148:151], v[60:63], v[80:95]
  s_waitcnt lgkmcnt(4)
  v_mfma_f32_32x32x16_bf16 v[96:111], v[152:155], v[60:63], v[96:111]
  s_waitcnt lgkmcnt(2)
  v_mfma_f32_32x32x16_bf16 v[112:127], v[156:159], v[60:63], v[112:127]
  s_waitcnt lgkmcnt(0)
  v_mfma_f32_32x32x16_bf16 v[128:143], v[160:163], v[60:63], v[128:143]
  s_waitcnt lgkmcnt(0)
  s_barrier
  s_mul_i32 s29, s24, 0x2800
  v_lshlrev_b32 v255, 4, v224
  v_add_u32 v255, s29, v255
  s_nop 2
  ds_write_b128 v255, v[104:107]
  ds_write_b128 v255, v[108:111] offset:1024
  ds_write_b128 v255, v[112:115] offset:2048
  ds_write_b128 v255, v[116:119] offset:3072
  ds_write_b128 v255, v[120:123] offset:4096
  ds_write_b128 v255, v[124:127] offset:5120
  ds_write_b128 v255, v[128:131] offset:6144
  ds_write_b128 v255, v[132:135] offset:7168
  ds_write_b128 v255, v[136:139] offset:8192
  ds_write_b128 v255, v[140:143] offset:9216
  s_waitcnt lgkmcnt(0)
  s_barrier
  v_add_u32 v255, 0xa000, v255
  ds_read_b128 v[0:3], v255
  ds_read_b128 v[4:7], v255 offset:1024
  ds_read_b128 v[8:11], v255 offset:2048
  ds_read_b128 v[12:15], v255 offset:3072
  ds_read_b128 v[16:19], v255 offset:4096
  ds_read_b128 v[20:23], v255 offset:5120
  ds_read_b128 v[24:27], v255 offset:6144
  ds_read_b128 v[28:31], v255 offset:7168
  ds_read_b128 v[32:35], v255 offset:8192
  ds_read_b128 v[36:39], v255 offset:9216
  s_lshl_b32 s29, s34, 3
  s_add_u32 s29, s29, s27
  s_lshl_b32 s29, s29, 2
  s_add_u32 s29, s29, s35
  s_lshl_b32 s29, s29, 2
  s_add_u32 s29, s29, s26
  s_mul_i32 s29, s29, 0x2800
  s_add_u32 s29, s29, 0
  v_lshlrev_b32 v253, 4, v224
  v_add_u32 v253, s29, v253
  s_waitcnt lgkmcnt(9)
  v_add_f32 v64, v64, v0
  v_add_f32 v65, v65, v1
  v_add_f32 v66, v66, v2
  v_add_f32 v67, v67, v3
  s_waitcnt lgkmcnt(8)
  v_add_f32 v68, v68, v4
  v_add_f32 v69, v69, v5
  v_add_f32 v70, v70, v6
  v_add_f32 v71, v71, v7
  s_waitcnt lgkmcnt(7)
  v_add_f32 v72, v72, v8
  v_add_f32 v73, v73, v9
  v_add_f32 v74, v74, v10
  v_add_f32 v75, v75, v11
  s_waitcnt lgkmcnt(6)
  v_add_f32 v76, v76, v12
  v_add_f32 v77, v77, v13
  v_add_f32 v78, v78, v14
  v_add_f32 v79, v79, v15
  s_waitcnt lgkmcnt(5)
  v_add_f32 v80, v80, v16
  v_add_f32 v81, v81, v17
  v_add_f32 v82, v82, v18
  v_add_f32 v83, v83, v19
  s_waitcnt lgkmcnt(4)
  v_add_f32 v84, v84, v20
  v_add_f32 v85, v85, v21
  v_add_f32 v86, v86, v22
  v_add_f32 v87, v87, v23
  s_waitcnt lgkmcnt(3)
  v_add_f32 v88, v88, v24
  v_add_f32 v89, v89, v25
  v_add_f32 v90, v90, v26
  v_add_f32 v91, v91, v27
  s_waitcnt lgkmcnt(2)
  v_add_f32 v92, v92, v28
  v_add_f32 v93, v93, v29
  v_add_f32 v94, v94, v30
  v_add_f32 v95, v95, v31
  s_waitcnt lgkmcnt(1)
  v_add_f32 v96, v96, v32
  v_add_f32 v97, v97, v33
  v_add_f32 v98, v98, v34
  v_add_f32 v99, v99, v35
  s_waitcnt lgkmcnt(0)
  v_add_f32 v100, v100, v36
  v_add_f32 v101, v101, v37
  v_add_f32 v102, v102, v38
  v_add_f32 v103, v103, v39
  v_cvt_pk_bf16_f32 v40, v64, v65
  v_cvt_pk_bf16_f32 v41, v66, v67
  v_cvt_pk_bf16_f32 v42, v68, v69
  v_cvt_pk_bf16_f32 v43, v70, v71
  buffer_store_dwordx4 v[40:43], v253, s[60:63], 0 offen
  v_cvt_pk_bf16_f32 v44, v72, v73
  v_cvt_pk_bf16_f32 v45, v74, v75
  v_cvt_pk_bf16_f32 v46, v76, v77
  v_cvt_pk_bf16_f32 v47, v78, v79
  buffer_store_dwordx4 v[44:47], v253, s[60:63], 0 offen offset:1024
  v_cvt_pk_bf16_f32 v48, v80, v81
  v_cvt_pk_bf16_f32 v49, v82, v83
  v_cvt_pk_bf16_f32 v50, v84, v85
  v_cvt_pk_bf16_f32 v51, v86, v87
  buffer_store_dwordx4 v[48:51], v253, s[60:63], 0 offen offset:2048
  v_cvt_pk_bf16_f32 v52, v88, v89
  v_cvt_pk_bf16_f32 v53, v90, v91
  v_cvt_pk_bf16_f32 v54, v92, v93
  v_cvt_pk_bf16_f32 v55, v94, v95
  buffer_store_dwordx4 v[52:55], v253, s[60:63], 0 offen offset:3072
  v_cvt_pk_bf16_f32 v56, v96, v97
  v_cvt_pk_bf16_f32 v57, v98, v99
  v_cvt_pk_bf16_f32 v58, v100, v101
  v_cvt_pk_bf16_f32 v59, v102, v103
  v_add_u32 v253, 0x1000, v253
  buffer_store_dwordx4 v[56:59], v253, s[60:63], 0 offen
  s_endpgm
.LK2ROLE1:
  v_lshlrev_b32 v253, 4, v224
  s_lshl_b32 s29, s27, 5
  s_add_u32 s29, s29, s34
  s_add_u32 s29, s29, 16
  s_lshl_b32 s29, s29, 2
  s_add_u32 s29, s29, s26
  s_lshl_b32 s29, s29, 13
  buffer_load_dwordx4 v[0:3], v253, s[20:23], s29 offen
  buffer_load_dwordx4 v[4:7], v253, s[20:23], s29 offen offset:1024
  buffer_load_dwordx4 v[8:11], v253, s[20:23], s29 offen offset:2048
  buffer_load_dwordx4 v[12:15], v253, s[20:23], s29 offen offset:3072
  s_add_u32 s29, s29, 0x1000
  buffer_load_dwordx4 v[16:19], v253, s[20:23], s29 offen
  buffer_load_dwordx4 v[20:23], v253, s[20:23], s29 offen offset:1024
  buffer_load_dwordx4 v[24:27], v253, s[20:23], s29 offen offset:2048
  buffer_load_dwordx4 v[28:31], v253, s[20:23], s29 offen offset:3072
  s_lshl_b32 s29, s27, 5
  s_add_u32 s29, s29, s34
  s_add_u32 s29, s29, 24
  s_lshl_b32 s29, s29, 2
  s_add_u32 s29, s29, s26
  s_lshl_b32 s29, s29, 13
  buffer_load_dwordx4 v[32:35], v253, s[20:23], s29 offen
  buffer_load_dwordx4 v[36:39], v253, s[20:23], s29 offen offset:1024
  buffer_load_dwordx4 v[40:43], v253, s[20:23], s29 offen offset:2048
  buffer_load_dwordx4 v[44:47], v253, s[20:23], s29 offen offset:3072
  s_add_u32 s29, s29, 0x1000
  buffer_load_dwordx4 v[48:51], v253, s[20:23], s29 offen
  buffer_load_dwordx4 v[52:55], v253, s[20:23], s29 offen offset:1024
  buffer_load_dwordx4 v[56:59], v253, s[20:23], s29 offen offset:2048
  buffer_load_dwordx4 v[60:63], v253, s[20:23], s29 offen offset:3072
  v_lshlrev_b32 v250, 4, v224
  v_add_u32 v250, 0, v250
  v_mul_u32_u24 v251, 0xccd, v250
  v_lshrrev_b32 v251, 20, v251
  v_mul_u32_u24 v252, 0x140, v251
  v_sub_u32 v252, v250, v252
  v_mul_u32_u24 v251, 0x500, v251
  v_add_u32 v251, v251, v252
  s_mul_i32 s29, s35, 0x140
  s_add_u32 s29, s29, 0
  v_add_u32 v204, s29, v251
  v_lshlrev_b32 v250, 4, v224
  v_add_u32 v250, 0x400, v250
  v_mul_u32_u24 v251, 0xccd, v250
  v_lshrrev_b32 v251, 20, v251
  v_mul_u32_u24 v252, 0x140, v251
  v_sub_u32 v252, v250, v252
  v_mul_u32_u24 v251, 0x500, v251
  v_add_u32 v251, v251, v252
  s_mul_i32 s29, s35, 0x140
  s_add_u32 s29, s29, 0xfffffc00
  v_add_u32 v205, s29, v251
  v_lshlrev_b32 v250, 4, v224
  v_add_u32 v250, 0x800, v250
  v_mul_u32_u24 v251, 0xccd, v250
  v_lshrrev_b32 v251, 20, v251
  v_mul_u32_u24 v252, 0x140, v251
  v_sub_u32 v252, v250, v252
  v_mul_u32_u24 v251, 0x500, v251
  v_add_u32 v251, v251, v252
  s_mul_i32 s29, s35, 0x140
  s_add_u32 s29, s29, 0xfffff800
  v_add_u32 v206, s29, v251
  v_lshlrev_b32 v250, 4, v224
  v_add_u32 v250, 0xc00, v250
  v_mul_u32_u24 v251, 0xccd, v250
  v_lshrrev_b32 v251, 20, v251
  v_mul_u32_u24 v252, 0x140, v251
  v_sub_u32 v252, v250, v252
  v_mul_u32_u24 v251, 0x500, v251
  v_add_u32 v251, v251, v252
  s_mul_i32 s29, s35, 0x140
  s_add_u32 s29, s29, 0xfffff400
  v_add_u32 v207, s29, v251
  v_lshlrev_b32 v250, 4, v224
  v_add_u32 v250, 0x1000, v250
  v_mul_u32_u24 v251, 0xccd, v250
  v_lshrrev_b32 v251, 20, v251
  v_mul_u32_u24 v252, 0x140, v251
  v_sub_u32 v252, v250, v252
  v_mul_u32_u24 v251, 0x500, v251
  v_add_u32 v251, v251, v252
  s_mul_i32 s29, s35, 0x140
  s_add_u32 s29, s29, 0
  v_add_u32 v208, s29, v251
  s_lshl_b32 s29, s25, 1
  s_add_u32 s29, s29, 0
  s_lshl_b32 s30, s29, 7
  s_lshl_b32 s33, s26, 5
  s_add_u32 s30, s30, s33
  s_mul_i32 s30, s30, 0x140
  s_lshl_b32 s29, s29, 3
  s_add_u32 s29, s29, s34
  s_lshl_b32 s29, s29, 7
  s_add_u32 s29, s29, s33
  s_mul_i32 s29, s29, 0x500
  s_add_u32 m0, s30, 0
  s_nop 0
  buffer_load_dwordx4 v204, s[56:59], s29 offen lds
  buffer_load_dwordx4 v205, s[56:59], s29 offen offset:1024 lds
  buffer_load_dwordx4 v206, s[56:59], s29 offen offset:2048 lds
  buffer_load_dwordx4 v207, s[56:59], s29 offen offset:3072 lds
  s_add_u32 m0, s30, 0x1000
  s_nop 0
  buffer_load_dwordx4 v208, s[56:59], s29 offen lds
  s_add_u32 s29, s29, 0x5000
  s_add_u32 m0, s30, 0x1400
  s_nop 0
  buffer_load_dwordx4 v204, s[56:59], s29 offen lds
  buffer_load_dwordx4 v205, s[56:59], s29 offen offset:1024 lds
  buffer_load_dwordx4 v206, s[56:59], s29 offen offset:2048 lds
  buffer_load_dwordx4 v207, s[56:59], s29 offen offset:3072 lds
  s_add_u32 m0, s30, 0x2400
  s_nop 0
  buffer_load_dwordx4 v208, s[56:59], s29 offen lds
  s_lshl_b32 s29, s25, 1
  s_add_u32 s29, s29, 1
  s_lshl_b32 s30, s29, 7
  s_lshl_b32 s33, s26, 5
  s_add_u32 s30, s30, s33
  s_mul_i32 s30, s30, 0x140
  s_lshl_b32 s29, s29, 3
  s_add_u32 s29, s29, s34
  s_lshl_b32 s29, s29, 7
  s_add_u32 s29, s29, s33
  s_mul_i32 s29, s29, 0x500
  s_add_u32 m0, s30, 0
  s_nop 0
  buffer_load_dwordx4 v204, s[56:59], s29 offen lds
  buffer_load_dwordx4 v205, s[56:59], s29 offen offset:1024 lds
  buffer_load_dwordx4 v206, s[56:59], s29 offen offset:2048 lds
  buffer_load_dwordx4 v207, s[56:59], s29 offen offset:3072 lds
  s_add_u32 m0, s30, 0x1000
  s_nop 0
  buffer_load_dwordx4 v208, s[56:59], s29 offen lds
  s_add_u32 s29, s29, 0x5000
  s_add_u32 m0, s30, 0x1400
  s_nop 0
  buffer_load_dwordx4 v204, s[56:59], s29 offen lds
  buffer_load_dwordx4 v205, s[56:59], s29 offen offset:1024 lds
  buffer_load_dwordx4 v206, s[56:59], s29 offen offset:2048 lds
  buffer_load_dwordx4 v207, s[56:59], s29 offen offset:3072 lds
  s_add_u32 m0, s30, 0x2400
  s_nop 0
  buffer_load_dwordx4 v208, s[56:59], s29 offen lds
  v_lshrrev_b32 v251, 5, v224
  v_lshrrev_b32 v250, 2, v224
  v_and_b32 v250, 3, v250
  v_lshl_add_u32 v250, v251, 3, v250
  v_add_u32 v250, 0x100, v250
  v_mul_u32_u24 v250, 0x140, v250
  v_and_b32 v251, 1, v224
  v_lshl_add_u32 v250, v251, 4, v250
  v_and_b32 v251, 2, v224
  v_lshl_add_u32 v250, v251, 2, v250
  v_and_b32 v251, 16, v224
  v_lshl_add_u32 v227, v251, 1, v250
  s_waitcnt vmcnt(10)
  s_barrier
  ds_read_b64_tr_b16 v[144:145], v227
  ds_read_b64_tr_b16 v[146:147], v227 offset:1280
  ds_read_b64_tr_b16 v[148:149], v227 offset:64
  ds_read_b64_tr_b16 v[150:151], v227 offset:1344
  ds_read_b64_tr_b16 v[152:153], v227 offset:128
  ds_read_b64_tr_b16 v[154:155], v227 offset:1408
  ds_read_b64_tr_b16 v[156:157], v227 offset:192
  ds_read_b64_tr_b16 v[158:159], v227 offset:1472
  ds_read_b64_tr_b16 v[160:161], v227 offset:256
  ds_read_b64_tr_b16 v[162:163], v227 offset:1536
  ds_read_b64_tr_b16 v[164:165], v227 offset:5120
  ds_read_b64_tr_b16 v[166:167], v227 offset:6400
  ds_read_b64_tr_b16 v[168:169], v227 offset:5184
  ds_read_b64_tr_b16 v[170:171], v227 offset:6464
  ds_read_b64_tr_b16 v[172:173], v227 offset:5248
  ds_read_b64_tr_b16 v[174:175], v227 offset:6528
  ds_read_b64_tr_b16 v[176:177], v227 offset:5312
  ds_read_b64_tr_b16 v[178:179], v227 offset:6592
  ds_read_b64_tr_b16 v[180:181], v227 offset:5376
  ds_read_b64_tr_b16 v[182:183], v227 offset:6656
  ds_read_b64_tr_b16 v[184:185], v227 offset:10240
  ds_read_b64_tr_b16 v[186:187], v227 offset:11520
  ds_read_b64_tr_b16 v[188:189], v227 offset:10304
  ds_read_b64_tr_b16 v[190:191], v227 offset:11584
  ds_read_b64_tr_b16 v[192:193], v227 offset:10368
  ds_read_b64_tr_b16 v[194:195], v227 offset:11648
  ds_read_b64_tr_b16 v[196:197], v227 offset:10432
  ds_read_b64_tr_b16 v[198:199], v227 offset:11712
  ds_read_b64_tr_b16 v[200:201], v227 offset:10496
  ds_read_b64_tr_b16 v[202:203], v227 offset:11776
  s_waitcnt lgkmcnt(15)
  v_mfma_f32_32x32x16_bf16 v[64:79], v[144:147], v[0:3], 0
  v_mfma_f32_32x32x16_bf16 v[80:95], v[148:151], v[0:3], 0
  v_mfma_f32_32x32x16_bf16 v[96:111], v[152:155], v[0:3], 0
  v_mfma_f32_32x32x16_bf16 v[112:127], v[156:159], v[0:3], 0
  v_mfma_f32_32x32x16_bf16 v[128:143], v[160:163], v[0:3], 0
  ds_read_b64_tr_b16 v[144:145], v227 offset:15360
  ds_read_b64_tr_b16 v[146:147], v227 offset:16640
  ds_read_b64_tr_b16 v[148:149], v227 offset:15424
  ds_read_b64_tr_b16 v[150:151], v227 offset:16704
  ds_read_b64_tr_b16 v[152:153], v227 offset:15488
  ds_read_b64_tr_b16 v[154:155], v227 offset:16768
  ds_read_b64_tr_b16 v[156:157], v227 offset:15552
  ds_read_b64_tr_b16 v[158:159], v227 offset:16832
  ds_read_b64_tr_b16 v[160:161], v227 offset:15616
  ds_read_b64_tr_b16 v[162:163], v227 offset:16896
  v_mfma_f32_32x32x16_bf16 v[64:79], v[164:167], v[4:7], v[64:79]
  v_mfma_f32_32x32x16_bf16 v[80:95], v[168:171], v[4:7], v[80:95]
  s_waitcnt lgkmcnt(15)
  v_mfma_f32_32x32x16_bf16 v[96:111], v[172:175], v[4:7], v[96:111]
  v_mfma_f32_32x32x16_bf16 v[112:127], v[176:179], v[4:7], v[112:127]
  v_mfma_f32_32x32x16_bf16 v[128:143], v[180:183], v[4:7], v[128:143]
  ds_read_b64_tr_b16 v[164:165], v227 offset:20480
  ds_read_b64_tr_b16 v[166:167], v227 offset:21760
  ds_read_b64_tr_b16 v[168:169], v227 offset:20544
  ds_read_b64_tr_b16 v[170:171], v227 offset:21824
  ds_read_b64_tr_b16 v[172:173], v227 offset:20608
  ds_read_b64_tr_b16 v[174:175], v227 offset:21888
  ds_read_b64_tr_b16 v[176:177], v227 offset:20672
  ds_read_b64_tr_b16 v[178:179], v227 offset:21952
  ds_read_b64_tr_b16 v[180:181], v227 offset:20736
  ds_read_b64_tr_b16 v[182:183], v227 offset:22016
  v_mfma_f32_32x32x16_bf16 v[64:79], v[184:187], v[8:11], v[64:79]
  v_mfma_f32_32x32x16_bf16 v[80:95], v[188:191], v[8:11], v[80:95]
  s_waitcnt lgkmcnt(15)
  v_mfma_f32_32x32x16_bf16 v[96:111], v[192:195], v[8:11], v[96:111]
  v_mfma_f32_32x32x16_bf16 v[112:127], v[196:199], v[8:11], v[112:127]
  v_mfma_f32_32x32x16_bf16 v[128:143], v[200:203], v[8:11], v[128:143]
  ds_read_b64_tr_b16 v[184:185], v227 offset:25600
  ds_read_b64_tr_b16 v[186:187], v227 offset:26880
  ds_read_b64_tr_b16 v[188:189], v227 offset:25664
  ds_read_b64_tr_b16 v[190:191], v227 offset:26944
  ds_read_b64_tr_b16 v[192:193], v227 offset:25728
  ds_read_b64_tr_b16 v[194:195], v227 offset:27008
  ds_read_b64_tr_b16 v[196:197], v227 offset:25792
  ds_read_b64_tr_b16 v[198:199], v227 offset:27072
  ds_read_b64_tr_b16 v[200:201], v227 offset:25856
  ds_read_b64_tr_b16 v[202:203], v227 offset:27136
  v_mfma_f32_32x32x16_bf16 v[64:79], v[144:147], v[12:15], v[64:79]
  v_mfma_f32_32x32x16_bf16 v[80:95], v[148:151], v[12:15], v[80:95]
  s_waitcnt lgkmcnt(15)
  v_mfma_f32_32x32x16_bf16 v[96:111], v[152:155], v[12:15], v[96:111]
  v_mfma_f32_32x32x16_bf16 v[112:127], v[156:159], v[12:15], v[112:127]
  v_mfma_f32_32x32x16_bf16 v[128:143], v[160:163], v[12:15], v[128:143]
  ds_read_b64_tr_b16 v[144:145], v227 offset:30720
  ds_read_b64_tr_b16 v[146:147], v227 offset:32000
  ds_read_b64_tr_b16 v[148:149], v227 offset:30784
  ds_read_b64_tr_b16 v[150:151], v227 offset:32064
  ds_read_b64_tr_b16 v[152:153], v227 offset:30848
  ds_read_b64_tr_b16 v[154:155], v227 offset:32128
  ds_read_b64_tr_b16 v[156:157], v227 offset:30912
  ds_read_b64_tr_b16 v[158:159], v227 offset:32192
  ds_read_b64_tr_b16 v[160:161], v227 offset:30976
  ds_read_b64_tr_b16 v[162:163], v227 offset:32256
  v_mfma_f32_32x32x16_bf16 v[64:79], v[164:167], v[16:19], v[64:79]
  v_mfma_f32_32x32x16_bf16 v[80:95], v[168:171], v[16:19], v[80:95]
  s_waitcnt lgkmcnt(15)
  v_mfma_f32_32x32x16_bf16 v[96:111], v[172:175], v[16:19], v[96:111]
  v_mfma_f32_32x32x16_bf16 v[112:127], v[176:179], v[16:19], v[112:127]
  v_mfma_f32_32x32x16_bf16 v[128:143], v[180:183], v[16:19], v[128:143]
  ds_read_b64_tr_b16 v[164:165], v227 offset:35840
  ds_read_b64_tr_b16 v[166:167], v227 offset:37120
  ds_read_b64_tr_b16 v[168:169], v227 offset:35904
  ds_read_b64_tr_b16 v[170:171], v227 offset:37184
  ds_read_b64_tr_b16 v[172:173], v227 offset:35968
  ds_read_b64_tr_b16 v[174:175], v227 offset:37248
  ds_read_b64_tr_b16 v[176:177], v227 offset:36032
  ds_read_b64_tr_b16 v[178:179], v227 offset:37312
  ds_read_b64_tr_b16 v[180:181], v227 offset:36096
  ds_read_b64_tr_b16 v[182:183], v227 offset:37376
  v_mfma_f32_32x32x16_bf16 v[64:79], v[184:187], v[20:23], v[64:79]
  v_mfma_f32_32x32x16_bf16 v[80:95], v[188:191], v[20:23], v[80:95]
  s_waitcnt lgkmcnt(15)
  v_mfma_f32_32x32x16_bf16 v[96:111], v[192:195], v[20:23], v[96:111]
  v_mfma_f32_32x32x16_bf16 v[112:127], v[196:199], v[20:23], v[112:127]
  v_mfma_f32_32x32x16_bf16 v[128:143], v[200:203], v[20:23], v[128:143]
  s_waitcnt vmcnt(0)
  s_barrier
  v_add_u32 v227, 0xa000, v227
  ds_read_b64_tr_b16 v[184:185], v227
  ds_read_b64_tr_b16 v[186:187], v227 offset:1280
  ds_read_b64_tr_b16 v[188:189], v227 offset:64
  ds_read_b64_tr_b16 v[190:191], v227 offset:1344
  ds_read_b64_tr_b16 v[192:193], v227 offset:128
  ds_read_b64_tr_b16 v[194:195], v227 offset:1408
  ds_read_b64_tr_b16 v[196:197], v227 offset:192
  ds_read_b64_tr_b16 v[198:199], v227 offset:1472
  ds_read_b64_tr_b16 v[200:201], v227 offset:256
  ds_read_b64_tr_b16 v[202:203], v227 offset:1536
  v_mfma_f32_32x32x16_bf16 v[64:79], v[144:147], v[24:27], v[64:79]
  v_mfma_f32_32x32x16_bf16 v[80:95], v[148:151], v[24:27], v[80:95]
  s_waitcnt lgkmcnt(15)
  v_mfma_f32_32x32x16_bf16 v[96:111], v[152:155], v[24:27], v[96:111]
  v_mfma_f32_32x32x16_bf16 v[112:127], v[156:159], v[24:27], v[112:127]
  v_mfma_f32_32x32x16_bf16 v[128:143], v[160:163], v[24:27], v[128:143]
  ds_read_b64_tr_b16 v[144:145], v227 offset:5120
  ds_read_b64_tr_b16 v[146:147], v227 offset:6400
  ds_read_b64_tr_b16 v[148:149], v227 offset:5184
  ds_read_b64_tr_b16 v[150:151], v227 offset:6464
  ds_read_b64_tr_b16 v[152:153], v227 offset:5248
  ds_read_b64_tr_b16 v[154:155], v227 offset:6528
  ds_read_b64_tr_b16 v[156:157], v227 offset:5312
  ds_read_b64_tr_b16 v[158:159], v227 offset:6592
  ds_read_b64_tr_b16 v[160:161], v227 offset:5376
  ds_read_b64_tr_b16 v[162:163], v227 offset:6656
  v_mfma_f32_32x32x16_bf16 v[64:79], v[164:167], v[28:31], v[64:79]
  v_mfma_f32_32x32x16_bf16 v[80:95], v[168:171], v[28:31], v[80:95]
  s_waitcnt lgkmcnt(15)
  v_mfma_f32_32x32x16_bf16 v[96:111], v[172:175], v[28:31], v[96:111]
  v_mfma_f32_32x32x16_bf16 v[112:127], v[176:179], v[28:31], v[112:127]
  v_mfma_f32_32x32x16_bf16 v[128:143], v[180:183], v[28:31], v[128:143]
  ds_read_b64_tr_b16 v[164:165], v227 offset:10240
  ds_read_b64_tr_b16 v[166:167], v227 offset:11520
  ds_read_b64_tr_b16 v[168:169], v227 offset:10304
  ds_read_b64_tr_b16 v[170:171], v227 offset:11584
  ds_read_b64_tr_b16 v[172:173], v227 offset:10368
  ds_read_b64_tr_b16 v[174:175], v227 offset:11648
  ds_read_b64_tr_b16 v[176:177], v227 offset:10432
  ds_read_b64_tr_b16 v[178:179], v227 offset:11712
  ds_read_b64_tr_b16 v[180:181], v227 offset:10496
  ds_read_b64_tr_b16 v[182:183], v227 offset:11776
  v_mfma_f32_32x32x16_bf16 v[64:79], v[184:187], v[32:35], v[64:79]
  v_mfma_f32_32x32x16_bf16 v[80:95], v[188:191], v[32:35], v[80:95]
  s_waitcnt lgkmcnt(15)
  v_mfma_f32_32x32x16_bf16 v[96:111], v[192:195], v[32:35], v[96:111]
  v_mfma_f32_32x32x16_bf16 v[112:127], v[196:199], v[32:35], v[112:127]
  v_mfma_f32_32x32x16_bf16 v[128:143], v[200:203], v[32:35], v[128:143]
  ds_read_b64_tr_b16 v[184:185], v227 offset:15360
  ds_read_b64_tr_b16 v[186:187], v227 offset:16640
  ds_read_b64_tr_b16 v[188:189], v227 offset:15424
  ds_read_b64_tr_b16 v[190:191], v227 offset:16704
  ds_read_b64_tr_b16 v[192:193], v227 offset:15488
  ds_read_b64_tr_b16 v[194:195], v227 offset:16768
  ds_read_b64_tr_b16 v[196:197], v227 offset:15552
  ds_read_b64_tr_b16 v[198:199], v227 offset:16832
  ds_read_b64_tr_b16 v[200:201], v227 offset:15616
  ds_read_b64_tr_b16 v[202:203], v227 offset:16896
  v_mfma_f32_32x32x16_bf16 v[64:79], v[144:147], v[36:39], v[64:79]
  v_mfma_f32_32x32x16_bf16 v[80:95], v[148:151], v[36:39], v[80:95]
  s_waitcnt lgkmcnt(15)
  v_mfma_f32_32x32x16_bf16 v[96:111], v[152:155], v[36:39], v[96:111]
  v_mfma_f32_32x32x16_bf16 v[112:127], v[156:159], v[36:39], v[112:127]
  v_mfma_f32_32x32x16_bf16 v[128:143], v[160:163], v[36:39], v[128:143]
  ds_read_b64_tr_b16 v[144:145], v227 offset:20480
  ds_read_b64_tr_b16 v[146:147], v227 offset:21760
  ds_read_b64_tr_b16 v[148:149], v227 offset:20544
  ds_read_b64_tr_b16 v[150:151], v227 offset:21824
  ds_read_b64_tr_b16 v[152:153], v227 offset:20608
  ds_read_b64_tr_b16 v[154:155], v227 offset:21888
  ds_read_b64_tr_b16 v[156:157], v227 offset:20672
  ds_read_b64_tr_b16 v[158:159], v227 offset:21952
  ds_read_b64_tr_b16 v[160:161], v227 offset:20736
  ds_read_b64_tr_b16 v[162:163], v227 offset:22016
  v_mfma_f32_32x32x16_bf16 v[64:79], v[164:167], v[40:43], v[64:79]
  v_mfma_f32_32x32x16_bf16 v[80:95], v[168:171], v[40:43], v[80:95]
  s_waitcnt lgkmcnt(15)
  v_mfma_f32_32x32x16_bf16 v[96:111], v[172:175], v[40:43], v[96:111]
  v_mfma_f32_32x32x16_bf16 v[112:127], v[176:179], v[40:43], v[112:127]
  v_mfma_f32_32x32x16_bf16 v[128:143], v[180:183], v[40:43], v[128:143]
  ds_read_b64_tr_b16 v[164:165], v227 offset:25600
  ds_read_b64_tr_b16 v[166:167], v227 offset:26880
  ds_read_b64_tr_b16 v[168:169], v227 offset:25664
  ds_read_b64_tr_b16 v[170:171], v227 offset:26944
  ds_read_b64_tr_b16 v[172:173], v227 offset:25728
  ds_read_b64_tr_b16 v[174:175], v227 offset:27008
  ds_read_b64_tr_b16 v[176:177], v227 offset:25792
  ds_read_b64_tr_b16 v[178:179], v227 offset:27072
  ds_read_b64_tr_b16 v[180:181], v227 offset:25856
  ds_read_b64_tr_b16 v[182:183], v227 offset:27136
  v_mfma_f32_32x32x16_bf16 v[64:79], v[184:187], v[44:47], v[64:79]
  v_mfma_f32_32x32x16_bf16 v[80:95], v[188:191], v[44:47], v[80:95]
  s_waitcnt lgkmcnt(15)
  v_mfma_f32_32x32x16_bf16 v[96:111], v[192:195], v[44:47], v[96:111]
  v_mfma_f32_32x32x16_bf16 v[112:127], v[196:199], v[44:47], v[112:127]
  v_mfma_f32_32x32x16_bf16 v[128:143], v[200:203], v[44:47], v[128:143]
  ds_read_b64_tr_b16 v[184:185], v227 offset:30720
  ds_read_b64_tr_b16 v[186:187], v227 offset:32000
  ds_read_b64_tr_b16 v[188:189], v227 offset:30784
  ds_read_b64_tr_b16 v[190:191], v227 offset:32064
  ds_read_b64_tr_b16 v[192:193], v227 offset:30848
  ds_read_b64_tr_b16 v[194:195], v227 offset:32128
  ds_read_b64_tr_b16 v[196:197], v227 offset:30912
  ds_read_b64_tr_b16 v[198:199], v227 offset:32192
  ds_read_b64_tr_b16 v[200:201], v227 offset:30976
  ds_read_b64_tr_b16 v[202:203], v227 offset:32256
  v_mfma_f32_32x32x16_bf16 v[64:79], v[144:147], v[48:51], v[64:79]
  v_mfma_f32_32x32x16_bf16 v[80:95], v[148:151], v[48:51], v[80:95]
  s_waitcnt lgkmcnt(15)
  v_mfma_f32_32x32x16_bf16 v[96:111], v[152:155], v[48:51], v[96:111]
  v_mfma_f32_32x32x16_bf16 v[112:127], v[156:159], v[48:51], v[112:127]
  v_mfma_f32_32x32x16_bf16 v[128:143], v[160:163], v[48:51], v[128:143]
  ds_read_b64_tr_b16 v[144:145], v227 offset:35840
  ds_read_b64_tr_b16 v[146:147], v227 offset:37120
  ds_read_b64_tr_b16 v[148:149], v227 offset:35904
  ds_read_b64_tr_b16 v[150:151], v227 offset:37184
  ds_read_b64_tr_b16 v[152:153], v227 offset:35968
  ds_read_b64_tr_b16 v[154:155], v227 offset:37248
  ds_read_b64_tr_b16 v[156:157], v227 offset:36032
  ds_read_b64_tr_b16 v[158:159], v227 offset:37312
  ds_read_b64_tr_b16 v[160:161], v227 offset:36096
  ds_read_b64_tr_b16 v[162:163], v227 offset:37376
  v_mfma_f32_32x32x16_bf16 v[64:79], v[164:167], v[52:55], v[64:79]
  v_mfma_f32_32x32x16_bf16 v[80:95], v[168:171], v[52:55], v[80:95]
  s_waitcnt lgkmcnt(15)
  v_mfma_f32_32x32x16_bf16 v[96:111], v[172:175], v[52:55], v[96:111]
  v_mfma_f32_32x32x16_bf16 v[112:127], v[176:179], v[52:55], v[112:127]
  v_mfma_f32_32x32x16_bf16 v[128:143], v[180:183], v[52:55], v[128:143]
  v_mfma_f32_32x32x16_bf16 v[64:79], v[184:187], v[56:59], v[64:79]
  v_mfma_f32_32x32x16_bf16 v[80:95], v[188:191], v[56:59], v[80:95]
  s_waitcnt lgkmcnt(14)
  v_mfma_f32_32x32x16_bf16 v[96:111], v[192:195], v[56:59], v[96:111]
  s_waitcnt lgkmcnt(12)
  v_mfma_f32_32x32x16_bf16 v[112:127], v[196:199], v[56:59], v[112:127]
  s_waitcnt lgkmcnt(10)
  v_mfma_f32_32x32x16_bf16 v[128:143], v[200:203], v[56:59], v[128:143]
  s_waitcnt lgkmcnt(8)
  v_mfma_f32_32x32x16_bf16 v[64:79], v[144:147], v[60:63], v[64:79]
  s_waitcnt lgkmcnt(6)
  v_mfma_f32_32x32x16_bf16 v[80:95], v[148:151], v[60:63], v[80:95]
  s_waitcnt lgkmcnt(4)
  v_mfma_f32_32x32x16_bf16 v[96:111], v[152:155], v[60:63], v[96:111]
  s_waitcnt lgkmcnt(2)
  v_mfma_f32_32x32x16_bf16 v[112:127], v[156:159], v[60:63], v[112:127]
  s_waitcnt lgkmcnt(0)
  v_mfma_f32_32x32x16_bf16 v[128:143], v[160:163], v[60:63], v[128:143]
  s_waitcnt lgkmcnt(0)
  s_barrier
  s_mul_i32 s29, s24, 0x2800
  v_lshlrev_b32 v255, 4, v224
  v_add_u32 v255, s29, v255
  ds_write_b128 v255, v[64:67]
  ds_write_b128 v255, v[68:71] offset:1024
  ds_write_b128 v255, v[72:75] offset:2048
  ds_write_b128 v255, v[76:79] offset:3072
  ds_write_b128 v255, v[80:83] offset:4096
  ds_write_b128 v255, v[84:87] offset:5120
  ds_write_b128 v255, v[88:91] offset:6144
  ds_write_b128 v255, v[92:95] offset:7168
  ds_write_b128 v255, v[96:99] offset:8192
  ds_write_b128 v255, v[100:103] offset:9216
  s_waitcnt lgkmcnt(0)
  s_barrier
  v_add_u32 v255, 0xffff6000, v255
  ds_read_b128 v[0:3], v255
  ds_read_b128 v[4:7], v255 offset:1024
  ds_read_b128 v[8:11], v255 offset:2048
  ds_read_b128 v[12:15], v255 offset:3072
  ds_read_b128 v[16:19], v255 offset:4096
  ds_read_b128 v[20:23], v255 offset:5120
  ds_read_b128 v[24:27], v255 offset:6144
  ds_read_b128 v[28:31], v255 offset:7168
  ds_read_b128 v[32:35], v255 offset:8192
  ds_read_b128 v[36:39], v255 offset:9216
  s_lshl_b32 s29, s34, 3
  s_add_u32 s29, s29, s27
  s_lshl_b32 s29, s29, 2
  s_add_u32 s29, s29, s35
  s_lshl_b32 s29, s29, 2
  s_add_u32 s29, s29, s26
  s_mul_i32 s29, s29, 0x2800
  s_add_u32 s29, s29, 0x1400
  v_lshlrev_b32 v253, 4, v224
  v_add_u32 v253, s29, v253
  s_waitcnt lgkmcnt(9)
  v_add_f32 v104, v104, v0
  v_add_f32 v105, v105, v1
  v_add_f32 v106, v106, v2
  v_add_f32 v107, v107, v3
  s_waitcnt lgkmcnt(8)
  v_add_f32 v108, v108, v4
  v_add_f32 v109, v109, v5
  v_add_f32 v110, v110, v6
  v_add_f32 v111, v111, v7
  s_waitcnt lgkmcnt(7)
  v_add_f32 v112, v112, v8
  v_add_f32 v113, v113, v9
  v_add_f32 v114, v114, v10
  v_add_f32 v115, v115, v11
  s_waitcnt lgkmcnt(6)
  v_add_f32 v116, v116, v12
  v_add_f32 v117, v117, v13
  v_add_f32 v118, v118, v14
  v_add_f32 v119, v119, v15
  s_waitcnt lgkmcnt(5)
  v_add_f32 v120, v120, v16
  v_add_f32 v121, v121, v17
  v_add_f32 v122, v122, v18
  v_add_f32 v123, v123, v19
  s_waitcnt lgkmcnt(4)
  v_add_f32 v124, v124, v20
  v_add_f32 v125, v125, v21
  v_add_f32 v126, v126, v22
  v_add_f32 v127, v127, v23
  s_waitcnt lgkmcnt(3)
  v_add_f32 v128, v128, v24
  v_add_f32 v129, v129, v25
  v_add_f32 v130, v130, v26
  v_add_f32 v131, v131, v27
  s_waitcnt lgkmcnt(2)
  v_add_f32 v132, v132, v28
  v_add_f32 v133, v133, v29
  v_add_f32 v134, v134, v30
  v_add_f32 v135, v135, v31
  s_waitcnt lgkmcnt(1)
  v_add_f32 v136, v136, v32
  v_add_f32 v137, v137, v33
  v_add_f32 v138, v138, v34
  v_add_f32 v139, v139, v35
  s_waitcnt lgkmcnt(0)
  v_add_f32 v140, v140, v36
  v_add_f32 v141, v141, v37
  v_add_f32 v142, v142, v38
  v_add_f32 v143, v143, v39
  v_cvt_pk_bf16_f32 v40, v104, v105
  v_cvt_pk_bf16_f32 v41, v106, v107
  v_cvt_pk_bf16_f32 v42, v108, v109
  v_cvt_pk_bf16_f32 v43, v110, v111
  buffer_store_dwordx4 v[40:43], v253, s[60:63], 0 offen
  v_cvt_pk_bf16_f32 v44, v112, v113
  v_cvt_pk_bf16_f32 v45, v114, v115
  v_cvt_pk_bf16_f32 v46, v116, v117
  v_cvt_pk_bf16_f32 v47, v118, v119
  buffer_store_dwordx4 v[44:47], v253, s[60:63], 0 offen offset:1024
  v_cvt_pk_bf16_f32 v48, v120, v121
  v_cvt_pk_bf16_f32 v49, v122, v123
  v_cvt_pk_bf16_f32 v50, v124, v125
  v_cvt_pk_bf16_f32 v51, v126, v127
  buffer_store_dwordx4 v[48:51], v253, s[60:63], 0 offen offset:2048
  v_cvt_pk_bf16_f32 v52, v128, v129
  v_cvt_pk_bf16_f32 v53, v130, v131
  v_cvt_pk_bf16_f32 v54, v132, v133
  v_cvt_pk_bf16_f32 v55, v134, v135
  buffer_store_dwordx4 v[52:55], v253, s[60:63], 0 offen offset:3072
  v_cvt_pk_bf16_f32 v56, v136, v137
  v_cvt_pk_bf16_f32 v57, v138, v139
  v_cvt_pk_bf16_f32 v58, v140, v141
  v_cvt_pk_bf16_f32 v59, v142, v143
  v_add_u32 v253, 0x1000, v253
  buffer_store_dwordx4 v[56:59], v253, s[60:63], 0 offen
  s_endpgm
.LEND_K2:
  s_endpgm
.globl reduce_kernel
.p2align 8
.type reduce_kernel,@function
reduce_kernel:
  s_load_dwordx2 s[36:37], s[0:1], 40
  s_load_dwordx2 s[44:45], s[0:1], 56
  s_cmp_ge_u32 s2, 0xa0
  s_cbranch_scc1 .LEND_K3
  v_and_b32 v100, 63, v0
  v_lshrrev_b32 v101, 6, v0
  s_nop 0
  v_readfirstlane_b32 s24, v101
  s_lshl_b32 s25, s2, 2
  s_nop 2
  s_add_u32 s25, s25, s24
  s_mul_hi_u32 s27, s25, 0x33333334
  s_mul_i32 s31, s27, 5
  s_sub_u32 s26, s25, s31
  s_and_b32 s28, s27, 3
  s_lshr_b32 s29, s27, 2
  s_and_b32 s29, s29, 3
  s_lshr_b32 s30, s27, 4
  s_waitcnt lgkmcnt(0)
  s_mov_b32 s31, 0x800000
  s_add_u32 s4, s44, s31
  s_addc_u32 s5, s45, 0
  s_and_b32 s5, s5, 0xffff
  s_mov_b32 s6, 0xa00000
  s_mov_b32 s7, 0x20000
  s_mov_b32 s8, s36
  s_and_b32 s9, s37, 0xffff
  s_mov_b32 s10, 0x118000
  s_mov_b32 s11, 0x20000
  s_mul_i32 s31, s27, 0x2800
  s_lshl_b32 s32, s26, 11
  s_add_u32 s31, s31, s32
  v_lshlrev_b32 v103, 4, v100
  v_add_u32 v103, s31, v103
  v_and_b32 v101, 31, v100
  s_lshl_b32 s31, s28, 5
  v_add_u32 v101, s31, v101
  v_cmp_gt_u32 vcc, 0x70, v101
  s_mul_i32 s31, s30, 0x70
  v_add_u32 v101, s31, v101
  v_mul_u32_u24 v101, 0x500, v101
  v_lshrrev_b32 v102, 5, v100
  v_lshl_add_u32 v101, v102, 4, v101
  s_mul_i32 s31, s29, 0x140
  s_lshl_b32 s32, s26, 6
  s_add_u32 s31, s31, s32
  v_add_u32 v104, s31, v101
  s_and_saveexec_b64 s[46:47], vcc
  s_cbranch_execz .LEND_K3
  s_mov_b32 s52, 0
  s_mov_b32 s53, 0x140000
  s_mov_b32 s54, 0x280000
  s_mov_b32 s55, 0x3c0000
  s_mov_b32 s56, 0x500000
  s_mov_b32 s57, 0x640000
  s_mov_b32 s58, 0x780000
  s_mov_b32 s59, 0x8c0000
  buffer_load_dwordx4 v[0:3], v103, s[4:7], s52 offen
  buffer_load_dwordx4 v[4:7], v103, s[4:7], s52 offen offset:1024
  buffer_load_dwordx4 v[8:11], v103, s[4:7], s53 offen
  buffer_load_dwordx4 v[12:15], v103, s[4:7], s53 offen offset:1024
  buffer_load_dwordx4 v[16:19], v103, s[4:7], s54 offen
  buffer_load_dwordx4 v[20:23], v103, s[4:7], s54 offen offset:1024
  buffer_load_dwordx4 v[24:27], v103, s[4:7], s55 offen
  buffer_load_dwordx4 v[28:31], v103, s[4:7], s55 offen offset:1024
  buffer_load_dwordx4 v[32:35], v103, s[4:7], s56 offen
  buffer_load_dwordx4 v[36:39], v103, s[4:7], s56 offen offset:1024
  buffer_load_dwordx4 v[40:43], v103, s[4:7], s57 offen
  buffer_load_dwordx4 v[44:47], v103, s[4:7], s57 offen offset:1024
  buffer_load_dwordx4 v[48:51], v103, s[4:7], s58 offen
  buffer_load_dwordx4 v[52:55], v103, s[4:7], s58 offen offset:1024
  buffer_load_dwordx4 v[56:59], v103, s[4:7], s59 offen
  buffer_load_dwordx4 v[60:63], v103, s[4:7], s59 offen offset:1024
  s_waitcnt vmcnt(14)
  v_lshlrev_b32 v64, 16, v0
  v_and_b32 v65, 0xffff0000, v0
  v_lshlrev_b32 v66, 16, v1
  v_and_b32 v67, 0xffff0000, v1
  v_lshlrev_b32 v68, 16, v2
  v_and_b32 v69, 0xffff0000, v2
  v_lshlrev_b32 v70, 16, v3
  v_and_b32 v71, 0xffff0000, v3
  v_lshlrev_b32 v72, 16, v4
  v_and_b32 v73, 0xffff0000, v4
  v_lshlrev_b32 v74, 16, v5
  v_and_b32 v75, 0xffff0000, v5
  v_lshlrev_b32 v76, 16, v6
  v_and_b32 v77, 0xffff0000, v6
  v_lshlrev_b32 v78, 16, v7
  v_and_b32 v79, 0xffff0000, v7
  s_waitcnt vmcnt(12)
  v_lshlrev_b32 v80, 16, v8
  v_and_b32 v81, 0xffff0000, v8
  v_add_f32 v64, v64, v80
  v_add_f32 v65, v65, v81
  v_lshlrev_b32 v80, 16, v9
  v_and_b32 v81, 0xffff0000, v9
  v_add_f32 v66, v66, v80
  v_add_f32 v67, v67, v81
  v_lshlrev_b32 v80, 16, v10
  v_and_b32 v81, 0xffff0000, v10
  v_add_f32 v68, v68, v80
  v_add_f32 v69, v69, v81
  v_lshlrev_b32 v80, 16, v11
  v_and_b32 v81, 0xffff0000, v11
  v_add_f32 v70, v70, v80
  v_add_f32 v71, v71, v81
  v_lshlrev_b32 v80, 16, v12
  v_and_b32 v81, 0xffff0000, v12
  v_add_f32 v72, v72, v80
  v_add_f32 v73, v73, v81
  v_lshlrev_b32 v80, 16, v13
  v_and_b32 v81, 0xffff0000, v13
  v_add_f32 v74, v74, v80
  v_add_f32 v75, v75, v81
  v_lshlrev_b32 v80, 16, v14
  v_and_b32 v81, 0xffff0000, v14
  v_add_f32 v76, v76, v80
  v_add_f32 v77, v77, v81
  v_lshlrev_b32 v80, 16, v15
  v_and_b32 v81, 0xffff0000, v15
  v_add_f32 v78, v78, v80
  v_add_f32 v79, v79, v81
  s_waitcnt vmcnt(10)
  v_lshlrev_b32 v80, 16, v16
  v_and_b32 v81, 0xffff0000, v16
  v_add_f32 v64, v64, v80
  v_add_f32 v65, v65, v81
  v_lshlrev_b32 v80, 16, v17
  v_and_b32 v81, 0xffff0000, v17
  v_add_f32 v66, v66, v80
  v_add_f32 v67, v67, v81
  v_lshlrev_b32 v80, 16, v18
  v_and_b32 v81, 0xffff0000, v18
  v_add_f32 v68, v68, v80
  v_add_f32 v69, v69, v81
  v_lshlrev_b32 v80, 16, v19
  v_and_b32 v81, 0xffff0000, v19
  v_add_f32 v70, v70, v80
  v_add_f32 v71, v71, v81
  v_lshlrev_b32 v80, 16, v20
  v_and_b32 v81, 0xffff0000, v20
  v_add_f32 v72, v72, v80
  v_add_f32 v73, v73, v81
  v_lshlrev_b32 v80, 16, v21
  v_and_b32 v81, 0xffff0000, v21
  v_add_f32 v74, v74, v80
  v_add_f32 v75, v75, v81
  v_lshlrev_b32 v80, 16, v22
  v_and_b32 v81, 0xffff0000, v22
  v_add_f32 v76, v76, v80
  v_add_f32 v77, v77, v81
  v_lshlrev_b32 v80, 16, v23
  v_and_b32 v81, 0xffff0000, v23
  v_add_f32 v78, v78, v80
  v_add_f32 v79, v79, v81
  s_waitcnt vmcnt(8)
  v_lshlrev_b32 v80, 16, v24
  v_and_b32 v81, 0xffff0000, v24
  v_add_f32 v64, v64, v80
  v_add_f32 v65, v65, v81
  v_lshlrev_b32 v80, 16, v25
  v_and_b32 v81, 0xffff0000, v25
  v_add_f32 v66, v66, v80
  v_add_f32 v67, v67, v81
  v_lshlrev_b32 v80, 16, v26
  v_and_b32 v81, 0xffff0000, v26
  v_add_f32 v68, v68, v80
  v_add_f32 v69, v69, v81
  v_lshlrev_b32 v80, 16, v27
  v_and_b32 v81, 0xffff0000, v27
  v_add_f32 v70, v70, v80
  v_add_f32 v71, v71, v81
  v_lshlrev_b32 v80, 16, v28
  v_and_b32 v81, 0xffff0000, v28
  v_add_f32 v72, v72, v80
  v_add_f32 v73, v73, v81
  v_lshlrev_b32 v80, 16, v29
  v_and_b32 v81, 0xffff0000, v29
  v_add_f32 v74, v74, v80
  v_add_f32 v75, v75, v81
  v_lshlrev_b32 v80, 16, v30
  v_and_b32 v81, 0xffff0000, v30
  v_add_f32 v76, v76, v80
  v_add_f32 v77, v77, v81
  v_lshlrev_b32 v80, 16, v31
  v_and_b32 v81, 0xffff0000, v31
  v_add_f32 v78, v78, v80
  v_add_f32 v79, v79, v81
  s_waitcnt vmcnt(6)
  v_lshlrev_b32 v80, 16, v32
  v_and_b32 v81, 0xffff0000, v32
  v_add_f32 v64, v64, v80
  v_add_f32 v65, v65, v81
  v_lshlrev_b32 v80, 16, v33
  v_and_b32 v81, 0xffff0000, v33
  v_add_f32 v66, v66, v80
  v_add_f32 v67, v67, v81
  v_lshlrev_b32 v80, 16, v34
  v_and_b32 v81, 0xffff0000, v34
  v_add_f32 v68, v68, v80
  v_add_f32 v69, v69, v81
  v_lshlrev_b32 v80, 16, v35
  v_and_b32 v81, 0xffff0000, v35
  v_add_f32 v70, v70, v80
  v_add_f32 v71, v71, v81
  v_lshlrev_b32 v80, 16, v36
  v_and_b32 v81, 0xffff0000, v36
  v_add_f32 v72, v72, v80
  v_add_f32 v73, v73, v81
  v_lshlrev_b32 v80, 16, v37
  v_and_b32 v81, 0xffff0000, v37
  v_add_f32 v74, v74, v80
  v_add_f32 v75, v75, v81
  v_lshlrev_b32 v80, 16, v38
  v_and_b32 v81, 0xffff0000, v38
  v_add_f32 v76, v76, v80
  v_add_f32 v77, v77, v81
  v_lshlrev_b32 v80, 16, v39
  v_and_b32 v81, 0xffff0000, v39
  v_add_f32 v78, v78, v80
  v_add_f32 v79, v79, v81
  s_waitcnt vmcnt(4)
  v_lshlrev_b32 v80, 16, v40
  v_and_b32 v81, 0xffff0000, v40
  v_add_f32 v64, v64, v80
  v_add_f32 v65, v65, v81
  v_lshlrev_b32 v80, 16, v41
  v_and_b32 v81, 0xffff0000, v41
  v_add_f32 v66, v66, v80
  v_add_f32 v67, v67, v81
  v_lshlrev_b32 v80, 16, v42
  v_and_b32 v81, 0xffff0000, v42
  v_add_f32 v68, v68, v80
  v_add_f32 v69, v69, v81
  v_lshlrev_b32 v80, 16, v43
  v_and_b32 v81, 0xffff0000, v43
  v_add_f32 v70, v70, v80
  v_add_f32 v71, v71, v81
  v_lshlrev_b32 v80, 16, v44
  v_and_b32 v81, 0xffff0000, v44
  v_add_f32 v72, v72, v80
  v_add_f32 v73, v73, v81
  v_lshlrev_b32 v80, 16, v45
  v_and_b32 v81, 0xffff0000, v45
  v_add_f32 v74, v74, v80
  v_add_f32 v75, v75, v81
  v_lshlrev_b32 v80, 16, v46
  v_and_b32 v81, 0xffff0000, v46
  v_add_f32 v76, v76, v80
  v_add_f32 v77, v77, v81
  v_lshlrev_b32 v80, 16, v47
  v_and_b32 v81, 0xffff0000, v47
  v_add_f32 v78, v78, v80
  v_add_f32 v79, v79, v81
  s_waitcnt vmcnt(2)
  v_lshlrev_b32 v80, 16, v48
  v_and_b32 v81, 0xffff0000, v48
  v_add_f32 v64, v64, v80
  v_add_f32 v65, v65, v81
  v_lshlrev_b32 v80, 16, v49
  v_and_b32 v81, 0xffff0000, v49
  v_add_f32 v66, v66, v80
  v_add_f32 v67, v67, v81
  v_lshlrev_b32 v80, 16, v50
  v_and_b32 v81, 0xffff0000, v50
  v_add_f32 v68, v68, v80
  v_add_f32 v69, v69, v81
  v_lshlrev_b32 v80, 16, v51
  v_and_b32 v81, 0xffff0000, v51
  v_add_f32 v70, v70, v80
  v_add_f32 v71, v71, v81
  v_lshlrev_b32 v80, 16, v52
  v_and_b32 v81, 0xffff0000, v52
  v_add_f32 v72, v72, v80
  v_add_f32 v73, v73, v81
  v_lshlrev_b32 v80, 16, v53
  v_and_b32 v81, 0xffff0000, v53
  v_add_f32 v74, v74, v80
  v_add_f32 v75, v75, v81
  v_lshlrev_b32 v80, 16, v54
  v_and_b32 v81, 0xffff0000, v54
  v_add_f32 v76, v76, v80
  v_add_f32 v77, v77, v81
  v_lshlrev_b32 v80, 16, v55
  v_and_b32 v81, 0xffff0000, v55
  v_add_f32 v78, v78, v80
  v_add_f32 v79, v79, v81
  s_waitcnt vmcnt(0)
  v_lshlrev_b32 v80, 16, v56
  v_and_b32 v81, 0xffff0000, v56
  v_add_f32 v64, v64, v80
  v_add_f32 v65, v65, v81
  v_lshlrev_b32 v80, 16, v57
  v_and_b32 v81, 0xffff0000, v57
  v_add_f32 v66, v66, v80
  v_add_f32 v67, v67, v81
  v_lshlrev_b32 v80, 16, v58
  v_and_b32 v81, 0xffff0000, v58
  v_add_f32 v68, v68, v80
  v_add_f32 v69, v69, v81
  v_lshlrev_b32 v80, 16, v59
  v_and_b32 v81, 0xffff0000, v59
  v_add_f32 v70, v70, v80
  v_add_f32 v71, v71, v81
  v_lshlrev_b32 v80, 16, v60
  v_and_b32 v81, 0xffff0000, v60
  v_add_f32 v72, v72, v80
  v_add_f32 v73, v73, v81
  v_lshlrev_b32 v80, 16, v61
  v_and_b32 v81, 0xffff0000, v61
  v_add_f32 v74, v74, v80
  v_add_f32 v75, v75, v81
  v_lshlrev_b32 v80, 16, v62
  v_and_b32 v81, 0xffff0000, v62
  v_add_f32 v76, v76, v80
  v_add_f32 v77, v77, v81
  v_lshlrev_b32 v80, 16, v63
  v_and_b32 v81, 0xffff0000, v63
  v_add_f32 v78, v78, v80
  v_add_f32 v79, v79, v81
  v_cvt_pk_bf16_f32 v84, v64, v65
  v_cvt_pk_bf16_f32 v85, v66, v67
  v_cvt_pk_bf16_f32 v86, v68, v69
  v_cvt_pk_bf16_f32 v87, v70, v71
  v_cvt_pk_bf16_f32 v88, v72, v73
  v_cvt_pk_bf16_f32 v89, v74, v75
  v_cvt_pk_bf16_f32 v90, v76, v77
  v_cvt_pk_bf16_f32 v91, v78, v79
  buffer_store_dwordx4 v[84:87], v104, s[8:11], 0 offen
  buffer_store_dwordx4 v[88:91], v104, s[8:11], 0 offen offset:32
.LEND_K3:
  s_endpgm
.section .rodata,"a"
.p2align 6
.amdhsa_kernel attn_kernel
  .amdhsa_next_free_vgpr 256
  .amdhsa_next_free_sgpr 100
  .amdhsa_accum_offset 256
  .amdhsa_group_segment_fixed_size 0
  .amdhsa_kernarg_size 64
  .amdhsa_user_sgpr_count 2
  .amdhsa_user_sgpr_kernarg_segment_ptr 1
  .amdhsa_system_sgpr_workgroup_id_x 1
.end_amdhsa_kernel
.p2align 6
.amdhsa_kernel oproj_kernel
  .amdhsa_next_free_vgpr 256
  .amdhsa_next_free_sgpr 100
  .amdhsa_accum_offset 256
  .amdhsa_group_segment_fixed_size 0
  .amdhsa_kernarg_size 64
  .amdhsa_user_sgpr_count 2
  .amdhsa_user_sgpr_kernarg_segment_ptr 1
  .amdhsa_system_sgpr_workgroup_id_x 1
.end_amdhsa_kernel
.p2align 6
.amdhsa_kernel reduce_kernel
  .amdhsa_next_free_vgpr 112
  .amdhsa_next_free_sgpr 96
  .amdhsa_accum_offset 112
  .amdhsa_group_segment_fixed_size 0
  .amdhsa_kernarg_size 64
  .amdhsa_user_sgpr_count 2
  .amdhsa_user_sgpr_kernarg_segment_ptr 1
  .amdhsa_system_sgpr_workgroup_id_x 1
.end_amdhsa_kernel
```
